```python
import torch

def _softmax(x, axis=-1):
    return torch.softmax(x, dim=axis)

def _gelu(x):
    return torch.nn.functional.gelu(x, approximate='tanh')

def _silu(x):
    return torch.nn.functional.silu(x)

def _sigmoid(x):
    return torch.sigmoid(x)

def _layernorm(x, axis=-1, eps=1e-05):
    m = x.mean(dim=axis, keepdim=True)
    v = x.var(dim=axis, keepdim=True, unbiased=False)
    return (x - m) / torch.sqrt(v + eps)

def _scatter_add(tgt, idx, src, axis=0):
    return tgt.clone().index_add_(axis, idx, src)

def _segment_sum(src, seg, n):
    out = torch.zeros((n,) + src.shape[1:], dtype=src.dtype)
    return out.index_add_(0, seg, src)

def _pad(x, pw):
    flat = tuple((v for pair in reversed(pw) for v in pair))
    return torch.nn.functional.pad(x, flat)
kernel_name = 'adaLN_cond__grouped_kv_mqa__swiglu_ffn__prompt'

def setup_inputs():

    _w = lambda a: (lambda t: t.to(torch.bfloat16) if t.is_floating_point() else t)(torch.as_tensor(a))

    def _A_setup():
        B, S, D, H = (1, 2048, 512, 32)
        Dh = D // H
        return {'x': _w((lambda *s: torch.randn(*s, dtype=torch.bfloat16) * 0.05)(B, S, D)), 'wq': _w((lambda *s: torch.randn(*s, dtype=torch.bfloat16) * 0.05)(D, H * Dh)), 'wk': _w((lambda *s: torch.randn(*s, dtype=torch.bfloat16) * 0.05)(D, Dh)), 'wv': _w((lambda *s: torch.randn(*s, dtype=torch.bfloat16) * 0.05)(D, Dh)), 'wo': _w((lambda *s: torch.randn(*s, dtype=torch.bfloat16) * 0.05)(H * Dh, D))}
    _A_in = _A_setup()

    def _B_setup():
        B, S, D, F = (1, 2048, 512, 1792)
        return {'x': _w((lambda *s: torch.randn(*s, dtype=torch.bfloat16) * 0.05)(B, S, D)), 'w_gate': _w((lambda *s: torch.randn(*s, dtype=torch.bfloat16) * 0.05)(D, F)), 'w_up': _w((lambda *s: torch.randn(*s, dtype=torch.bfloat16) * 0.05)(D, F)), 'w_down': _w((lambda *s: torch.randn(*s, dtype=torch.bfloat16) * 0.05)(F, D))}
    _B_in = _B_setup()
    return {'A_x': _A_in['x'], 'A_wq': _A_in['wq'], 'A_wk': _A_in['wk'], 'A_wv': _A_in['wv'], 'A_wo': _A_in['wo'], 'B_x': _B_in['x'], 'B_w_gate': _B_in['w_gate'], 'B_w_up': _B_in['w_up'], 'B_w_down': _B_in['w_down'], 'c': _w((lambda *s: torch.randn(*s, dtype=torch.bfloat16) * 0.1)(1, 512) * 8.0), 'w_mod': _w((lambda *s: torch.randn(*s, dtype=torch.bfloat16) * 0.1)(512, 6 * 512) * 512 ** (-0.5) * 8.0)}

def reference(A_x, A_wq, A_wk, A_wv, A_wo, B_x, B_w_gate, B_w_up, B_w_down, c, w_mod):

    def _A_ref(x, wq, wk, wv, wo):
        B, S, D = x.shape
        H = 32
        Dh = D // H
        q = (lambda x, *d: x.permute(*d))((x @ wq).reshape(B, S, H, Dh), 0, 2, 1, 3)
        k = x @ wk
        v = x @ wv
        scores = torch.einsum('bhqd,bkd->bhqk', q, k) * Dh ** (-0.5)
        p = _softmax(scores, axis=-1)
        o = torch.einsum('bhqk,bkd->bhqd', p, v)
        return (lambda x, *d: x.permute(*d))(o, 0, 2, 1, 3).reshape(B, S, H * Dh) @ wo

    def _B_ref(x, w_gate, w_up, w_down):
        g = _silu(x @ w_gate)
        u = x @ w_up
        return g * u @ w_down
    x = A_x
    mod = (_silu(c) @ w_mod).reshape(c.shape[0], 6, 1, -1)
    sa, ca, ga, sb, cb, gb = (mod[:, 0].clone(), mod[:, 1].clone(), mod[:, 2].clone(), mod[:, 3].clone(), mod[:, 4].clone(), mod[:, 5].clone())
    h = _layernorm(x, axis=-1) * (1 + ca) + sa
    x = x + ga * _A_ref(h, A_wq, A_wk, A_wv, A_wo)
    h = _layernorm(x, axis=-1) * (1 + cb) + sb
    x = x + gb * _B_ref(h, B_w_gate, B_w_up, B_w_down)
    return x
```

```asm
; @launch grid=(256,1,1) block=(512,1,1) lds=163840
.amdgcn_target "amdgcn-amd-amdhsa--gfx950"
.text
.globl adaLN_cond__grouped_kv_mqa__swiglu_ffn__prompt_kernel
.p2align 8
.type adaLN_cond__grouped_kv_mqa__swiglu_ffn__prompt_kernel,@function
adaLN_cond__grouped_kv_mqa__swiglu_ffn__prompt_kernel:
  s_cmp_ge_u32 s2, 256
  s_cbranch_scc1 L_exit
  s_load_dwordx16 s[4:19], s[0:1], 0
  s_load_dwordx8 s[20:27], s[0:1], 64
  s_load_dwordx4 s[28:31], s[0:1], 96
  v_lshrrev_b32 v2, 6, v0
  v_and_b32 v1, 63, v0
  s_and_b32 s90, s2, 7
  s_lshr_b32 s91, s2, 7
  s_lshl_b32 s54, s91, 3
  s_add_u32 s48, s90, s54
  s_lshr_b32 s49, s2, 3
  s_and_b32 s49, s49, 15
  s_lshr_b32 s50, s49, 3
  s_add_u32 s51, s49, 4
  s_and_b32 s51, s51, 7
  s_min_u32 s94, s49, 13
  v_readfirstlane_b32 s52, v2
  s_mov_b32 s92, 255
  s_cmp_lt_u32 s51, 4
  s_cbranch_scc1 L_nomb
  s_mov_b32 s54, s50
  s_cmp_eq_u32 s54, 0
  s_cbranch_scc0 L_nomb
  s_lshl_b32 s55, s91, 2
  s_add_u32 s55, s55, s90
  s_and_b32 s55, s55, 7
  s_sub_u32 s54, s51, 4
  s_lshl_b32 s92, s55, 2
  s_add_u32 s92, s92, s54
L_nomb:
  s_and_b32 s95, s52, 1
  s_lshr_b32 s87, s52, 1
  s_waitcnt lgkmcnt(0)
  s_mov_b32 s32, s30
  s_mov_b32 s33, s31
  s_mov_b32 s34, 268435456
  s_mov_b32 s35, 0x20000
  s_mov_b32 s44, s4
  s_mov_b32 s45, s5
  s_mov_b32 s46, 2097152
  s_mov_b32 s47, 0x20000
  v_mov_b32 v2, 0
  buffer_load_dword v3, v2, s[32:35], 0 offen sc1
  s_cmp_lt_u32 s92, 32
  s_cbranch_scc1 L_crit_1
  s_waitcnt vmcnt(0)
  v_readfirstlane_b32 s53, v3
  s_add_u32 s53, s53, 1
  s_lshl_b32 s54, s48, 7
  s_lshl_b32 s55, s50, 6
  s_add_u32 s54, s54, s55
  s_lshl_b32 s55, s52, 3
  s_add_u32 s54, s54, s55
  s_lshl_b32 s54, s54, 10
  v_lshlrev_b32 v7, 4, v1
  buffer_load_dwordx4 v[48:51], v7, s[44:47], s54 offen
  s_add_u32 s54, s54, 1024
  buffer_load_dwordx4 v[52:55], v7, s[44:47], s54 offen
  s_add_u32 s54, s54, 1024
  buffer_load_dwordx4 v[56:59], v7, s[44:47], s54 offen
  s_add_u32 s54, s54, 1024
  buffer_load_dwordx4 v[60:63], v7, s[44:47], s54 offen
  s_add_u32 s54, s54, 1024
  buffer_load_dwordx4 v[64:67], v7, s[44:47], s54 offen
  s_add_u32 s54, s54, 1024
  buffer_load_dwordx4 v[68:71], v7, s[44:47], s54 offen
  s_add_u32 s54, s54, 1024
  buffer_load_dwordx4 v[72:75], v7, s[44:47], s54 offen
  s_add_u32 s54, s54, 1024
  buffer_load_dwordx4 v[76:79], v7, s[44:47], s54 offen
  s_cmp_lg_u32 s51, 0
  s_cbranch_scc1 L_join_3
  v_lshrrev_b32 v6, 1, v1
  v_and_b32 v7, 1, v1
  v_lshlrev_b32 v7, 4, v7
  s_lshl_b32 s54, s52, 6
  v_add_u32 v8, s54, v6
  v_lshl_add_u32 v4, v8, 5, v7
  v_xor_b32 v9, 4, v6
  v_add_u32 v9, s54, v9
  v_lshl_add_u32 v5, v9, 5, v7
  s_lshl_b32 s56, s52, 11
  s_mov_b32 s40, s8
  s_mov_b32 s41, s9
  s_mov_b32 s42, 16384
  s_mov_b32 s43, 0x20000
  s_add_u32 m0, s56, 65536
  s_nop 0
  buffer_load_dwordx4 v4, s[40:43], 0 offen lds
  v_add_u32 v4, 1024, v4
  s_add_u32 m0, s56, 66560
  s_nop 0
  buffer_load_dwordx4 v4, s[40:43], 0 offen lds
  v_add_u32 v4, 1024, v4
  s_mov_b32 s40, s10
  s_mov_b32 s41, s11
  s_mov_b32 s42, 16384
  s_mov_b32 s43, 0x20000
  s_add_u32 m0, s56, 81920
  s_nop 0
  buffer_load_dwordx4 v5, s[40:43], 0 offen lds
  v_add_u32 v5, 1024, v5
  s_add_u32 m0, s56, 82944
  s_nop 0
  buffer_load_dwordx4 v5, s[40:43], 0 offen lds
  v_add_u32 v5, 1024, v5
  s_branch L_join_3
L_crit_1:
  s_mov_b32 s36, s24
  s_mov_b32 s37, s25
  s_mov_b32 s38, 3145728
  s_mov_b32 s39, 0x20000
  s_mov_b32 s40, s22
  s_mov_b32 s41, s23
  s_mov_b32 s42, 1024
  s_mov_b32 s43, 0x20000
  v_lshrrev_b32 v4, 2, v1
  v_lshlrev_b32 v5, 1, v4
  s_lshl_b32 s54, s52, 7
  v_add_u32 v5, s54, v5
  buffer_load_ushort v84, v5, s[40:43], 0 offen offset:0
  buffer_load_ushort v85, v5, s[40:43], 0 offen offset:32
  buffer_load_ushort v86, v5, s[40:43], 0 offen offset:64
  buffer_load_ushort v87, v5, s[40:43], 0 offen offset:96
  s_lshl_b32 s54, s52, 6
  v_add_u32 v6, s54, v4
  v_mul_u32_u24 v6, 6144, v6
  v_and_b32 v7, 3, v1
  v_lshlrev_b32 v7, 4, v7
  s_lshl_b32 s54, s92, 6
  v_add3_u32 v6, v6, v7, s54
  s_mov_b32 s54, 0
  buffer_load_dwordx4 v[16:19], v6, s[36:39], s54 offen
  s_add_u32 s54, s54, 98304
  buffer_load_dwordx4 v[20:23], v6, s[36:39], s54 offen
  s_add_u32 s54, s54, 98304
  buffer_load_dwordx4 v[24:27], v6, s[36:39], s54 offen
  s_add_u32 s54, s54, 98304
  buffer_load_dwordx4 v[28:31], v6, s[36:39], s54 offen
  s_waitcnt vmcnt(0)
  v_readfirstlane_b32 s53, v3
  s_add_u32 s53, s53, 1
  s_lshl_b32 s54, s48, 7
  s_lshl_b32 s55, s50, 6
  s_add_u32 s54, s54, s55
  s_lshl_b32 s55, s52, 3
  s_add_u32 s54, s54, s55
  s_lshl_b32 s54, s54, 10
  v_lshlrev_b32 v7, 4, v1
  buffer_load_dwordx4 v[48:51], v7, s[44:47], s54 offen
  s_add_u32 s54, s54, 1024
  buffer_load_dwordx4 v[52:55], v7, s[44:47], s54 offen
  s_add_u32 s54, s54, 1024
  buffer_load_dwordx4 v[56:59], v7, s[44:47], s54 offen
  s_add_u32 s54, s54, 1024
  buffer_load_dwordx4 v[60:63], v7, s[44:47], s54 offen
  s_add_u32 s54, s54, 1024
  buffer_load_dwordx4 v[64:67], v7, s[44:47], s54 offen
  s_add_u32 s54, s54, 1024
  buffer_load_dwordx4 v[68:71], v7, s[44:47], s54 offen
  s_add_u32 s54, s54, 1024
  buffer_load_dwordx4 v[72:75], v7, s[44:47], s54 offen
  s_add_u32 s54, s54, 1024
  buffer_load_dwordx4 v[76:79], v7, s[44:47], s54 offen
  v_lshlrev_b32 v84, 16, v84
  v_lshlrev_b32 v85, 16, v85
  v_lshlrev_b32 v86, 16, v86
  v_lshlrev_b32 v87, 16, v87
  v_mul_f32 v96, 0xbfb8aa3b, v84
  v_mul_f32 v97, 0xbfb8aa3b, v85
  v_mul_f32 v98, 0xbfb8aa3b, v86
  v_mul_f32 v99, 0xbfb8aa3b, v87
  v_exp_f32 v96, v96
  v_exp_f32 v97, v97
  v_exp_f32 v98, v98
  v_exp_f32 v99, v99
  v_add_f32 v96, 1.0, v96
  v_add_f32 v97, 1.0, v97
  v_add_f32 v98, 1.0, v98
  v_add_f32 v99, 1.0, v99
  v_rcp_f32 v96, v96
  v_rcp_f32 v97, v97
  v_rcp_f32 v98, v98
  v_rcp_f32 v99, v99
  v_mul_f32 v84, v84, v96
  v_mul_f32 v85, v85, v97
  v_mul_f32 v86, v86, v98
  v_mul_f32 v87, v87, v99
  v_cvt_pk_bf16_f32 v84, v84, 0
  v_cvt_pk_bf16_f32 v85, v85, 0
  v_cvt_pk_bf16_f32 v86, v86, 0
  v_cvt_pk_bf16_f32 v87, v87, 0
  v_lshlrev_b32 v96, 16, v84
  v_lshlrev_b32 v97, 16, v85
  v_lshlrev_b32 v98, 16, v86
  v_lshlrev_b32 v99, 16, v87
  v_dot2_f32_bf16 v100, v16, v84, 0
  v_dot2_f32_bf16 v101, v16, v96, 0
  v_dot2_f32_bf16 v102, v17, v84, 0
  v_dot2_f32_bf16 v103, v17, v96, 0
  v_dot2_f32_bf16 v104, v18, v84, 0
  v_dot2_f32_bf16 v105, v18, v96, 0
  v_dot2_f32_bf16 v106, v19, v84, 0
  v_dot2_f32_bf16 v107, v19, v96, 0
  v_dot2_f32_bf16 v100, v20, v85, v100
  v_dot2_f32_bf16 v101, v20, v97, v101
  v_dot2_f32_bf16 v102, v21, v85, v102
  v_dot2_f32_bf16 v103, v21, v97, v103
  v_dot2_f32_bf16 v104, v22, v85, v104
  v_dot2_f32_bf16 v105, v22, v97, v105
  v_dot2_f32_bf16 v106, v23, v85, v106
  v_dot2_f32_bf16 v107, v23, v97, v107
  v_dot2_f32_bf16 v100, v24, v86, v100
  v_dot2_f32_bf16 v101, v24, v98, v101
  v_dot2_f32_bf16 v102, v25, v86, v102
  v_dot2_f32_bf16 v103, v25, v98, v103
  v_dot2_f32_bf16 v104, v26, v86, v104
  v_dot2_f32_bf16 v105, v26, v98, v105
  v_dot2_f32_bf16 v106, v27, v86, v106
  v_dot2_f32_bf16 v107, v27, v98, v107
  v_dot2_f32_bf16 v100, v28, v87, v100
  v_dot2_f32_bf16 v101, v28, v99, v101
  v_dot2_f32_bf16 v102, v29, v87, v102
  v_dot2_f32_bf16 v103, v29, v99, v103
  v_dot2_f32_bf16 v104, v30, v87, v104
  v_dot2_f32_bf16 v105, v30, v99, v105
  v_dot2_f32_bf16 v106, v31, v87, v106
  v_dot2_f32_bf16 v107, v31, v99, v107
  v_permlane32_swap_b32 v100, v104
  v_permlane32_swap_b32 v101, v105
  v_permlane32_swap_b32 v102, v106
  v_permlane32_swap_b32 v103, v107
  v_add_f32 v100, v100, v104
  v_add_f32 v101, v101, v105
  v_add_f32 v102, v102, v106
  v_add_f32 v103, v103, v107
  s_nop 0
  v_permlane16_swap_b32 v100, v102
  v_permlane16_swap_b32 v101, v103
  v_add_f32 v100, v100, v102
  v_add_f32 v101, v101, v103
  s_nop 0
  v_add_f32_dpp v100, v100, v100 row_ror:8 row_mask:0xf bank_mask:0xf
  v_add_f32_dpp v101, v101, v101 row_ror:8 row_mask:0xf bank_mask:0xf
  s_nop 0
  v_add_f32_dpp v100, v100, v100 row_ror:4 row_mask:0xf bank_mask:0xf
  v_add_f32_dpp v101, v101, v101 row_ror:4 row_mask:0xf bank_mask:0xf
  v_and_b32 v4, 3, v1
  v_lshlrev_b32 v4, 2, v4
  v_lshrrev_b32 v5, 4, v1
  v_add_u32 v4, v4, v5
  v_lshlrev_b32 v4, 3, v4
  s_lshl_b32 s54, s52, 7
  s_add_u32 s54, s54, 131072
  v_add_u32 v4, s54, v4
  ds_write_b64 v4, v[100:101]
  s_waitcnt lgkmcnt(0)
  s_barrier
  s_cmp_lg_u32 s52, 0
  s_cbranch_scc1 L_modpub_4
  v_and_b32 v4, 15, v1
  v_lshlrev_b32 v4, 3, v4
  v_add_u32 v5, 131072, v4
  ds_read_b64 v[16:17], v5 offset:0
  ds_read_b64 v[18:19], v5 offset:128
  ds_read_b64 v[20:21], v5 offset:256
  ds_read_b64 v[22:23], v5 offset:384
  ds_read_b64 v[24:25], v5 offset:512
  ds_read_b64 v[26:27], v5 offset:640
  ds_read_b64 v[28:29], v5 offset:768
  ds_read_b64 v[30:31], v5 offset:896
  s_lshl_b32 s54, s92, 7
  s_add_u32 s54, s54, 524288
  v_lshrrev_b32 v5, 4, v1
  v_mul_u32_u24 v5, 16384, v5
  v_add3_u32 v5, v5, v4, s54
  s_waitcnt lgkmcnt(0)
  v_add_f32 v16, v16, v18
  v_add_f32 v17, v17, v19
  v_add_f32 v16, v16, v20
  v_add_f32 v17, v17, v21
  v_add_f32 v16, v16, v22
  v_add_f32 v17, v17, v23
  v_add_f32 v16, v16, v24
  v_add_f32 v17, v17, v25
  v_add_f32 v16, v16, v26
  v_add_f32 v17, v17, v27
  v_add_f32 v16, v16, v28
  v_add_f32 v17, v17, v29
  v_add_f32 v16, v16, v30
  v_add_f32 v17, v17, v31
  v_cvt_pk_bf16_f32 v6, v16, v17
  v_mov_b32 v7, s53
  s_mov_b32 s54, 65536
  buffer_store_dwordx2 v[6:7], v5, s[32:35], 0 offen sc1
  buffer_store_dwordx2 v[6:7], v5, s[32:35], s54 offen sc1
L_modpub_4:
L_join_3:
  s_cmp_lg_u32 s52, 7
  s_cbranch_scc1 L_ep_5
  s_mov_b64 exec, 1
  s_lshl_b32 s54, s2, 2
  s_add_u32 s54, s54, 1024
  v_mov_b32 v2, s54
  v_mov_b32 v3, s53
  buffer_store_dword v3, v2, s[32:35], 0 offen sc1
  s_mov_b64 exec, -1
  s_getpc_b64 s[96:97]
L_pcref:
  s_sub_u32 s96, s96, (L_pcref - adaLN_cond__grouped_kv_mqa__swiglu_ffn__prompt_kernel)
  s_subb_u32 s97, s97, 0
  s_lshr_b32 s54, s2, 3
  s_mul_i32 s54, s54, 1408
  v_lshlrev_b32 v4, 7, v1
  v_add_u32 v4, s54, v4
  s_mov_b32 s54, (L_codeend - adaLN_cond__grouped_kv_mqa__swiglu_ffn__prompt_kernel - 4)
  v_min_u32 v4, s54, v4
  s_mov_b64 exec, 2047
  global_load_dword v123, v4, s[96:97]
  s_mov_b64 exec, -1
L_ep_5:
  s_cmp_lg_u32 s52, 6
  s_cbranch_scc1 L_xccp_6
  s_getreg_b32 s54, hwreg(HW_REG_XCC_ID, 0, 4)
  s_lshl_b32 s55, s48, 7
  s_lshl_b32 s56, s49, 3
  s_add_u32 s55, s55, s56
  s_add_u32 s55, s55, 102400
  s_mov_b64 exec, 1
  v_mov_b32 v2, s55
  v_mov_b32 v4, s54
  v_mov_b32 v5, s53
  buffer_store_dwordx2 v[4:5], v2, s[32:35], 0 offen sc1
  s_mov_b64 exec, -1
L_xccp_6:
  s_cmp_eq_u32 s51, 0
  s_cselect_b32 s54, 4, 0
  s_cmp_ge_u32 s52, 6
  s_cselect_b32 s55, 1, 0
  s_add_u32 s54, s54, s55
  s_cmp_eq_u32 s52, 7
  s_cselect_b32 s55, 1, 0
  s_add_u32 s54, s54, s55
  s_cmp_lt_u32 s92, 32
  s_cselect_b32 s56, 2, 0
  s_cmp_eq_u32 s52, 0
  s_cselect_b32 s55, s56, 0
  s_add_u32 s54, s54, s55
  s_cmp_lg_u32 s54, 6
  s_cbranch_scc1 L_xw_8
  s_waitcnt vmcnt(6)
  s_branch L_xwd_7
L_xw_8:
  s_cmp_lg_u32 s54, 5
  s_cbranch_scc1 L_xw_9
  s_waitcnt vmcnt(5)
  s_branch L_xwd_7
L_xw_9:
  s_cmp_lg_u32 s54, 4
  s_cbranch_scc1 L_xw_10
  s_waitcnt vmcnt(4)
  s_branch L_xwd_7
L_xw_10:
  s_cmp_lg_u32 s54, 2
  s_cbranch_scc1 L_xw_11
  s_waitcnt vmcnt(2)
  s_branch L_xwd_7
L_xw_11:
  s_cmp_lg_u32 s54, 1
  s_cbranch_scc1 L_xw_12
  s_waitcnt vmcnt(1)
  s_branch L_xwd_7
L_xw_12:
  s_waitcnt vmcnt(0)
L_xwd_7:
  s_mov_b32 s36, s6
  s_mov_b32 s37, s7
  s_mov_b32 s38, 524288
  s_mov_b32 s39, 0x20000
  v_lshrrev_b32 v4, 3, v1
  v_bfe_u32 v6, v4, 1, 1
  v_lshlrev_b32 v6, 2, v6
  v_and_b32 v7, 7, v1
  v_xor_b32 v6, v6, v7
  v_lshlrev_b32 v6, 4, v6
  s_lshl_b32 s64, s52, 6
  v_add_u32 v7, s64, v4
  v_lshlrev_b32 v7, 10, v7
  s_lshl_b32 s64, s51, 7
  v_add3_u32 v120, v6, v7, s64
  s_lshl_b32 s65, s52, 13
  s_mov_b32 s64, 0
  v_mov_b32 v2, 0x3f803f80
  v_mov_b32 v3, 0x00003f80
  v_mov_b32 v4, 0x3f800000
  v_dot2_f32_bf16 v16, v48, v2, 0
  v_dot2_f32_bf16 v16, v49, v2, v16
  v_dot2_f32_bf16 v16, v50, v2, v16
  v_dot2_f32_bf16 v16, v51, v2, v16
  v_dot2_f32_bf16 v24, v48, v48, 0
  v_dot2_f32_bf16 v24, v49, v49, v24
  v_dot2_f32_bf16 v24, v50, v50, v24
  v_dot2_f32_bf16 v24, v51, v51, v24
  v_dot2_f32_bf16 v17, v52, v2, 0
  v_dot2_f32_bf16 v17, v53, v2, v17
  v_dot2_f32_bf16 v17, v54, v2, v17
  v_dot2_f32_bf16 v17, v55, v2, v17
  v_dot2_f32_bf16 v25, v52, v52, 0
  v_dot2_f32_bf16 v25, v53, v53, v25
  v_dot2_f32_bf16 v25, v54, v54, v25
  v_dot2_f32_bf16 v25, v55, v55, v25
  s_cmp_lt_u32 s52, 2
  s_cbranch_scc1 L_wqs_13
  s_add_u32 m0, s65, 0
  s_nop 0
  buffer_load_dwordx4 v120, s[36:39], s64 offen lds
  s_add_u32 s64, s64, 8192
L_wqs_13:
  v_dot2_f32_bf16 v18, v56, v2, 0
  v_dot2_f32_bf16 v18, v57, v2, v18
  v_dot2_f32_bf16 v18, v58, v2, v18
  v_dot2_f32_bf16 v18, v59, v2, v18
  v_dot2_f32_bf16 v26, v56, v56, 0
  v_dot2_f32_bf16 v26, v57, v57, v26
  v_dot2_f32_bf16 v26, v58, v58, v26
  v_dot2_f32_bf16 v26, v59, v59, v26
  v_dot2_f32_bf16 v19, v60, v2, 0
  v_dot2_f32_bf16 v19, v61, v2, v19
  v_dot2_f32_bf16 v19, v62, v2, v19
  v_dot2_f32_bf16 v19, v63, v2, v19
  v_dot2_f32_bf16 v27, v60, v60, 0
  v_dot2_f32_bf16 v27, v61, v61, v27
  v_dot2_f32_bf16 v27, v62, v62, v27
  v_dot2_f32_bf16 v27, v63, v63, v27
  s_cmp_lt_u32 s52, 2
  s_cbranch_scc1 L_wqs_14
  s_add_u32 m0, s65, 1024
  s_nop 0
  buffer_load_dwordx4 v120, s[36:39], s64 offen lds
  s_add_u32 s64, s64, 8192
L_wqs_14:
  v_dot2_f32_bf16 v20, v64, v2, 0
  v_dot2_f32_bf16 v20, v65, v2, v20
  v_dot2_f32_bf16 v20, v66, v2, v20
  v_dot2_f32_bf16 v20, v67, v2, v20
  v_dot2_f32_bf16 v28, v64, v64, 0
  v_dot2_f32_bf16 v28, v65, v65, v28
  v_dot2_f32_bf16 v28, v66, v66, v28
  v_dot2_f32_bf16 v28, v67, v67, v28
  v_dot2_f32_bf16 v21, v68, v2, 0
  v_dot2_f32_bf16 v21, v69, v2, v21
  v_dot2_f32_bf16 v21, v70, v2, v21
  v_dot2_f32_bf16 v21, v71, v2, v21
  v_dot2_f32_bf16 v29, v68, v68, 0
  v_dot2_f32_bf16 v29, v69, v69, v29
  v_dot2_f32_bf16 v29, v70, v70, v29
  v_dot2_f32_bf16 v29, v71, v71, v29
  s_cmp_lt_u32 s52, 2
  s_cbranch_scc1 L_wqs_15
  s_add_u32 m0, s65, 2048
  s_nop 0
  buffer_load_dwordx4 v120, s[36:39], s64 offen lds
  s_add_u32 s64, s64, 8192
L_wqs_15:
  v_dot2_f32_bf16 v22, v72, v2, 0
  v_dot2_f32_bf16 v22, v73, v2, v22
  v_dot2_f32_bf16 v22, v74, v2, v22
  v_dot2_f32_bf16 v22, v75, v2, v22
  v_dot2_f32_bf16 v30, v72, v72, 0
  v_dot2_f32_bf16 v30, v73, v73, v30
  v_dot2_f32_bf16 v30, v74, v74, v30
  v_dot2_f32_bf16 v30, v75, v75, v30
  v_dot2_f32_bf16 v23, v76, v2, 0
  v_dot2_f32_bf16 v23, v77, v2, v23
  v_dot2_f32_bf16 v23, v78, v2, v23
  v_dot2_f32_bf16 v23, v79, v2, v23
  v_dot2_f32_bf16 v31, v76, v76, 0
  v_dot2_f32_bf16 v31, v77, v77, v31
  v_dot2_f32_bf16 v31, v78, v78, v31
  v_dot2_f32_bf16 v31, v79, v79, v31
  s_cmp_lt_u32 s52, 2
  s_cbranch_scc1 L_wqs_16
  s_add_u32 m0, s65, 3072
  s_nop 0
  buffer_load_dwordx4 v120, s[36:39], s64 offen lds
  s_add_u32 s64, s64, 8192
L_wqs_16:
  v_permlane32_swap_b32 v16, v20
  v_permlane32_swap_b32 v17, v21
  v_permlane32_swap_b32 v18, v22
  v_permlane32_swap_b32 v19, v23
  v_permlane32_swap_b32 v24, v28
  v_permlane32_swap_b32 v25, v29
  v_permlane32_swap_b32 v26, v30
  v_permlane32_swap_b32 v27, v31
  v_add_f32 v16, v16, v20
  v_add_f32 v17, v17, v21
  v_add_f32 v18, v18, v22
  v_add_f32 v19, v19, v23
  v_add_f32 v24, v24, v28
  v_add_f32 v25, v25, v29
  v_add_f32 v26, v26, v30
  v_add_f32 v27, v27, v31
  v_permlane16_swap_b32 v16, v18
  v_permlane16_swap_b32 v17, v19
  v_permlane16_swap_b32 v24, v26
  v_permlane16_swap_b32 v25, v27
  v_add_f32 v16, v16, v18
  v_add_f32 v17, v17, v19
  v_add_f32 v24, v24, v26
  v_add_f32 v25, v25, v27
  v_add_f32_dpp v16, v16, v16 row_ror:8 row_mask:0xf bank_mask:0xf
  v_add_f32_dpp v17, v17, v17 row_ror:8 row_mask:0xf bank_mask:0xf
  v_add_f32_dpp v24, v24, v24 row_ror:8 row_mask:0xf bank_mask:0xf
  v_add_f32_dpp v25, v25, v25 row_ror:8 row_mask:0xf bank_mask:0xf
  v_add_f32_dpp v16, v16, v16 row_ror:4 row_mask:0xf bank_mask:0xf
  v_add_f32_dpp v17, v17, v17 row_ror:4 row_mask:0xf bank_mask:0xf
  v_add_f32_dpp v24, v24, v24 row_ror:4 row_mask:0xf bank_mask:0xf
  v_add_f32_dpp v25, v25, v25 row_ror:4 row_mask:0xf bank_mask:0xf
  v_add_f32_dpp v16, v16, v16 row_ror:2 row_mask:0xf bank_mask:0xf
  v_add_f32_dpp v17, v17, v17 row_ror:2 row_mask:0xf bank_mask:0xf
  v_add_f32_dpp v24, v24, v24 row_ror:2 row_mask:0xf bank_mask:0xf
  v_add_f32_dpp v25, v25, v25 row_ror:2 row_mask:0xf bank_mask:0xf
  v_add_f32_dpp v16, v16, v16 row_ror:1 row_mask:0xf bank_mask:0xf
  v_add_f32_dpp v17, v17, v17 row_ror:1 row_mask:0xf bank_mask:0xf
  v_add_f32_dpp v24, v24, v24 row_ror:1 row_mask:0xf bank_mask:0xf
  v_add_f32_dpp v25, v25, v25 row_ror:1 row_mask:0xf bank_mask:0xf
  v_mul_f32 v16, 0x3b000000, v16
  v_mul_f32 v24, 0x3b000000, v24
  v_fma_f32 v24, -v16, v16, v24
  v_max_f32 v24, 0, v24
  v_add_f32 v24, 0x3727c5ac, v24
  v_rsq_f32 v24, v24
  v_sub_f32 v16, 0, v16
  v_mul_f32 v17, 0x3b000000, v17
  v_mul_f32 v25, 0x3b000000, v25
  v_fma_f32 v25, -v17, v17, v25
  v_max_f32 v25, 0, v25
  v_add_f32 v25, 0x3727c5ac, v25
  v_rsq_f32 v25, v25
  v_sub_f32 v17, 0, v17
  v_readlane_b32 s70, v16, 0
  v_readlane_b32 s78, v24, 0
  v_readlane_b32 s71, v17, 0
  v_readlane_b32 s79, v25, 0
  v_readlane_b32 s72, v16, 16
  v_readlane_b32 s80, v24, 16
  v_readlane_b32 s73, v17, 16
  v_readlane_b32 s81, v25, 16
  v_readlane_b32 s74, v16, 32
  v_readlane_b32 s82, v24, 32
  v_readlane_b32 s75, v17, 32
  v_readlane_b32 s83, v25, 32
  v_readlane_b32 s76, v16, 48
  v_readlane_b32 s84, v24, 48
  v_readlane_b32 s77, v17, 48
  v_readlane_b32 s85, v25, 48
  v_mov_b32 v16, s70
  v_mov_b32 v17, s71
  v_mov_b32 v18, s72
  v_mov_b32 v19, s73
  v_mov_b32 v20, s74
  v_mov_b32 v21, s75
  v_mov_b32 v22, s76
  v_mov_b32 v23, s77
  v_dot2_f32_bf16 v128, v48, v3, v16
  v_dot2_f32_bf16 v129, v48, v4, v16
  v_dot2_f32_bf16 v130, v49, v3, v16
  v_dot2_f32_bf16 v131, v49, v4, v16
  v_dot2_f32_bf16 v132, v50, v3, v16
  v_dot2_f32_bf16 v133, v50, v4, v16
  v_dot2_f32_bf16 v134, v51, v3, v16
  v_dot2_f32_bf16 v135, v51, v4, v16
  v_dot2_f32_bf16 v136, v52, v3, v17
  v_dot2_f32_bf16 v137, v52, v4, v17
  v_dot2_f32_bf16 v138, v53, v3, v17
  v_dot2_f32_bf16 v139, v53, v4, v17
  v_dot2_f32_bf16 v140, v54, v3, v17
  v_dot2_f32_bf16 v141, v54, v4, v17
  v_dot2_f32_bf16 v142, v55, v3, v17
  v_dot2_f32_bf16 v143, v55, v4, v17
  s_cmp_lt_u32 s52, 2
  s_cbranch_scc1 L_wqs_17
  s_add_u32 m0, s65, 4096
  s_nop 0
  buffer_load_dwordx4 v120, s[36:39], s64 offen lds
  s_add_u32 s64, s64, 8192
L_wqs_17:
  v_dot2_f32_bf16 v144, v56, v3, v18
  v_dot2_f32_bf16 v145, v56, v4, v18
  v_dot2_f32_bf16 v146, v57, v3, v18
  v_dot2_f32_bf16 v147, v57, v4, v18
  v_dot2_f32_bf16 v148, v58, v3, v18
  v_dot2_f32_bf16 v149, v58, v4, v18
  v_dot2_f32_bf16 v150, v59, v3, v18
  v_dot2_f32_bf16 v151, v59, v4, v18
  v_dot2_f32_bf16 v152, v60, v3, v19
  v_dot2_f32_bf16 v153, v60, v4, v19
  v_dot2_f32_bf16 v154, v61, v3, v19
  v_dot2_f32_bf16 v155, v61, v4, v19
  v_dot2_f32_bf16 v156, v62, v3, v19
  v_dot2_f32_bf16 v157, v62, v4, v19
  v_dot2_f32_bf16 v158, v63, v3, v19
  v_dot2_f32_bf16 v159, v63, v4, v19
  s_cmp_lt_u32 s52, 2
  s_cbranch_scc1 L_wqs_18
  s_add_u32 m0, s65, 5120
  s_nop 0
  buffer_load_dwordx4 v120, s[36:39], s64 offen lds
  s_add_u32 s64, s64, 8192
L_wqs_18:
  v_dot2_f32_bf16 v160, v64, v3, v20
  v_dot2_f32_bf16 v161, v64, v4, v20
  v_dot2_f32_bf16 v162, v65, v3, v20
  v_dot2_f32_bf16 v163, v65, v4, v20
  v_dot2_f32_bf16 v164, v66, v3, v20
  v_dot2_f32_bf16 v165, v66, v4, v20
  v_dot2_f32_bf16 v166, v67, v3, v20
  v_dot2_f32_bf16 v167, v67, v4, v20
  v_dot2_f32_bf16 v168, v68, v3, v21
  v_dot2_f32_bf16 v169, v68, v4, v21
  v_dot2_f32_bf16 v170, v69, v3, v21
  v_dot2_f32_bf16 v171, v69, v4, v21
  v_dot2_f32_bf16 v172, v70, v3, v21
  v_dot2_f32_bf16 v173, v70, v4, v21
  v_dot2_f32_bf16 v174, v71, v3, v21
  v_dot2_f32_bf16 v175, v71, v4, v21
  s_cmp_lt_u32 s52, 2
  s_cbranch_scc1 L_wqs_19
  s_add_u32 m0, s65, 6144
  s_nop 0
  buffer_load_dwordx4 v120, s[36:39], s64 offen lds
  s_add_u32 s64, s64, 8192
L_wqs_19:
  v_dot2_f32_bf16 v176, v72, v3, v22
  v_dot2_f32_bf16 v177, v72, v4, v22
  v_dot2_f32_bf16 v178, v73, v3, v22
  v_dot2_f32_bf16 v179, v73, v4, v22
  v_dot2_f32_bf16 v180, v74, v3, v22
  v_dot2_f32_bf16 v181, v74, v4, v22
  v_dot2_f32_bf16 v182, v75, v3, v22
  v_dot2_f32_bf16 v183, v75, v4, v22
  v_dot2_f32_bf16 v184, v76, v3, v23
  v_dot2_f32_bf16 v185, v76, v4, v23
  v_dot2_f32_bf16 v186, v77, v3, v23
  v_dot2_f32_bf16 v187, v77, v4, v23
  v_dot2_f32_bf16 v188, v78, v3, v23
  v_dot2_f32_bf16 v189, v78, v4, v23
  v_dot2_f32_bf16 v190, v79, v3, v23
  v_dot2_f32_bf16 v191, v79, v4, v23
  s_cmp_lt_u32 s52, 2
  s_cbranch_scc1 L_wqs_20
  s_add_u32 m0, s65, 7168
  s_nop 0
  buffer_load_dwordx4 v120, s[36:39], s64 offen lds
  s_add_u32 s64, s64, 8192
L_wqs_20:
  v_mul_f32 v128, s78, v128
  v_mul_f32 v129, s78, v129
  v_mul_f32 v130, s78, v130
  v_mul_f32 v131, s78, v131
  v_mul_f32 v132, s78, v132
  v_mul_f32 v133, s78, v133
  v_mul_f32 v134, s78, v134
  v_mul_f32 v135, s78, v135
  v_mul_f32 v136, s79, v136
  v_mul_f32 v137, s79, v137
  v_mul_f32 v138, s79, v138
  v_mul_f32 v139, s79, v139
  v_mul_f32 v140, s79, v140
  v_mul_f32 v141, s79, v141
  v_mul_f32 v142, s79, v142
  v_mul_f32 v143, s79, v143
  v_mul_f32 v144, s80, v144
  v_mul_f32 v145, s80, v145
  v_mul_f32 v146, s80, v146
  v_mul_f32 v147, s80, v147
  v_mul_f32 v148, s80, v148
  v_mul_f32 v149, s80, v149
  v_mul_f32 v150, s80, v150
  v_mul_f32 v151, s80, v151
  v_mul_f32 v152, s81, v152
  v_mul_f32 v153, s81, v153
  v_mul_f32 v154, s81, v154
  v_mul_f32 v155, s81, v155
  v_mul_f32 v156, s81, v156
  v_mul_f32 v157, s81, v157
  v_mul_f32 v158, s81, v158
  v_mul_f32 v159, s81, v159
  v_mul_f32 v160, s82, v160
  v_mul_f32 v161, s82, v161
  v_mul_f32 v162, s82, v162
  v_mul_f32 v163, s82, v163
  v_mul_f32 v164, s82, v164
  v_mul_f32 v165, s82, v165
  v_mul_f32 v166, s82, v166
  v_mul_f32 v167, s82, v167
  v_mul_f32 v168, s83, v168
  v_mul_f32 v169, s83, v169
  v_mul_f32 v170, s83, v170
  v_mul_f32 v171, s83, v171
  v_mul_f32 v172, s83, v172
  v_mul_f32 v173, s83, v173
  v_mul_f32 v174, s83, v174
  v_mul_f32 v175, s83, v175
  v_mul_f32 v176, s84, v176
  v_mul_f32 v177, s84, v177
  v_mul_f32 v178, s84, v178
  v_mul_f32 v179, s84, v179
  v_mul_f32 v180, s84, v180
  v_mul_f32 v181, s84, v181
  v_mul_f32 v182, s84, v182
  v_mul_f32 v183, s84, v183
  v_mul_f32 v184, s85, v184
  v_mul_f32 v185, s85, v185
  v_mul_f32 v186, s85, v186
  v_mul_f32 v187, s85, v187
  v_mul_f32 v188, s85, v188
  v_mul_f32 v189, s85, v189
  v_mul_f32 v190, s85, v190
  v_mul_f32 v191, s85, v191
  s_and_b32 s54, s52, 1
  s_lshl_b32 s54, s54, 3
  s_lshl_b32 s55, s52, 13
  s_add_u32 s55, s55, 98304
  s_add_u32 s56, s54, 0
  v_xor_b32 v112, s56, v1
  v_lshlrev_b32 v112, 4, v112
  v_add_u32 v112, s55, v112
  s_add_u32 s56, s54, 1
  v_xor_b32 v113, s56, v1
  v_lshlrev_b32 v113, 4, v113
  v_add_u32 v113, s55, v113
  s_add_u32 s56, s54, 2
  v_xor_b32 v114, s56, v1
  v_lshlrev_b32 v114, 4, v114
  v_add_u32 v114, s55, v114
  s_add_u32 s56, s54, 3
  v_xor_b32 v115, s56, v1
  v_lshlrev_b32 v115, 4, v115
  v_add_u32 v115, s55, v115
  s_add_u32 s56, s54, 4
  v_xor_b32 v116, s56, v1
  v_lshlrev_b32 v116, 4, v116
  v_add_u32 v116, s55, v116
  s_add_u32 s56, s54, 5
  v_xor_b32 v117, s56, v1
  v_lshlrev_b32 v117, 4, v117
  v_add_u32 v117, s55, v117
  s_add_u32 s56, s54, 6
  v_xor_b32 v118, s56, v1
  v_lshlrev_b32 v118, 4, v118
  v_add_u32 v118, s55, v118
  s_add_u32 s56, s54, 7
  v_xor_b32 v119, s56, v1
  v_lshlrev_b32 v119, 4, v119
  v_add_u32 v119, s55, v119
  s_cmp_lg_u32 s52, 2
  s_cbranch_scc1 L_xccskip_21
  s_lshl_b32 s54, s48, 7
  s_add_u32 s54, s54, 102400
  v_and_b32 v2, 15, v1
  v_lshlrev_b32 v2, 3, v2
  v_add_u32 v2, s54, v2
  s_mov_b32 s86, 400000
L_poll_22:
  buffer_load_dwordx2 v[4:5], v2, s[32:35], 0 offen sc1
  s_waitcnt vmcnt(0)
  v_cmp_ne_u32 vcc, s53, v5
  s_sub_u32 s86, s86, 1
  s_cmp_eq_u32 s86, 0
  s_cbranch_scc1 L_pollout_23
  s_cbranch_vccnz L_poll_22
L_pollout_23:
  v_readfirstlane_b32 s54, v4
  s_mov_b32 s55, 0
  s_nop 1
  v_cmp_ne_u32 vcc, s54, v4
  s_cmp_eq_u32 s86, 0
  s_cbranch_scc1 L_xccskip_21w
  s_cbranch_vccnz L_xccskip_21w
  s_mov_b32 s55, 1
L_xccskip_21w:
  v_mov_b32 v2, 110592
  v_mov_b32 v3, s55
  ds_write_b32 v2, v3
  s_waitcnt lgkmcnt(0)
L_xccskip_21:
  s_cmp_ge_u32 s52, 2
  s_cbranch_scc1 L_nopoll_24
  s_mul_i32 s54, s90, 16384
  s_lshl_b32 s55, s52, 11
  s_add_u32 s54, s54, s55
  s_add_u32 s54, s54, 524288
  v_lshlrev_b32 v2, 5, v1
  v_add_u32 v2, s54, v2
  s_mov_b32 s86, 400000
L_poll_25:
  buffer_load_dwordx4 v[4:7], v2, s[32:35], 0 offen sc1
  buffer_load_dwordx4 v[8:11], v2, s[32:35], 0 offen offset:16 sc1
  s_waitcnt vmcnt(0)
  v_cmp_ne_u32 vcc, s53, v5
  v_cmp_ne_u32 s[96:97], s53, v7
  s_or_b64 vcc, vcc, s[96:97]
  v_cmp_ne_u32 s[96:97], s53, v9
  s_or_b64 vcc, vcc, s[96:97]
  v_cmp_ne_u32 s[96:97], s53, v11
  s_or_b64 vcc, vcc, s[96:97]
  s_sub_u32 s86, s86, 1
  s_cmp_eq_u32 s86, 0
  s_cbranch_scc1 L_pollout_26
  s_cbranch_vccnz L_poll_25
L_pollout_26:
  v_lshlrev_b32 v16, 16, v4
  v_and_b32 v17, 0xffff0000, v4
  v_lshlrev_b32 v18, 16, v6
  v_and_b32 v19, 0xffff0000, v6
  v_lshlrev_b32 v20, 16, v8
  v_and_b32 v21, 0xffff0000, v8
  v_lshlrev_b32 v22, 16, v10
  v_and_b32 v23, 0xffff0000, v10
  s_cmp_eq_u32 s52, 0
  s_cbranch_scc1 L_sa_27
  v_add_f32 v16, 1.0, v16
  v_add_f32 v17, 1.0, v17
  v_add_f32 v18, 1.0, v18
  v_add_f32 v19, 1.0, v19
  v_add_f32 v20, 1.0, v20
  v_add_f32 v21, 1.0, v21
  v_add_f32 v22, 1.0, v22
  v_add_f32 v23, 1.0, v23
  v_cvt_pk_bf16_f32 v4, v16, v17
  v_cvt_pk_bf16_f32 v5, v18, v19
  v_cvt_pk_bf16_f32 v6, v20, v21
  v_cvt_pk_bf16_f32 v7, v22, v23
  v_lshlrev_b32 v16, 16, v4
  v_and_b32 v17, 0xffff0000, v4
  v_lshlrev_b32 v18, 16, v5
  v_and_b32 v19, 0xffff0000, v5
  v_lshlrev_b32 v20, 16, v6
  v_and_b32 v21, 0xffff0000, v6
  v_lshlrev_b32 v22, 16, v7
  v_and_b32 v23, 0xffff0000, v7
L_sa_27:
  v_lshlrev_b32 v2, 5, v1
  s_lshl_b32 s54, s52, 11
  s_add_u32 s54, s54, 106496
  v_add_u32 v2, s54, v2
  ds_write_b128 v2, v[16:19]
  ds_write_b128 v2, v[20:23] offset:16
  s_waitcnt lgkmcnt(0)
L_nopoll_24:
  s_barrier
  v_lshlrev_b32 v2, 5, v1
  v_add_u32 v2, 106496, v2
  ds_read_b128 v[16:19], v2
  ds_read_b128 v[20:23], v2 offset:16
  ds_read_b128 v[24:27], v2 offset:2048
  ds_read_b128 v[28:31], v2 offset:2064
  v_mov_b32 v2, 110592
  ds_read_b32 v32, v2
  s_cmp_ge_u32 s52, 2
  s_cbranch_scc1 L_wqlate_28
  s_add_u32 m0, s65, 0
  s_nop 0
  buffer_load_dwordx4 v120, s[36:39], s64 offen lds
  s_add_u32 s64, s64, 8192
  s_add_u32 m0, s65, 1024
  s_nop 0
  buffer_load_dwordx4 v120, s[36:39], s64 offen lds
  s_add_u32 s64, s64, 8192
  s_add_u32 m0, s65, 2048
  s_nop 0
  buffer_load_dwordx4 v120, s[36:39], s64 offen lds
  s_add_u32 s64, s64, 8192
  s_add_u32 m0, s65, 3072
  s_nop 0
  buffer_load_dwordx4 v120, s[36:39], s64 offen lds
  s_add_u32 s64, s64, 8192
  s_add_u32 m0, s65, 4096
  s_nop 0
  buffer_load_dwordx4 v120, s[36:39], s64 offen lds
  s_add_u32 s64, s64, 8192
  s_add_u32 m0, s65, 5120
  s_nop 0
  buffer_load_dwordx4 v120, s[36:39], s64 offen lds
  s_add_u32 s64, s64, 8192
  s_add_u32 m0, s65, 6144
  s_nop 0
  buffer_load_dwordx4 v120, s[36:39], s64 offen lds
  s_add_u32 s64, s64, 8192
  s_add_u32 m0, s65, 7168
  s_nop 0
  buffer_load_dwordx4 v120, s[36:39], s64 offen lds
  s_add_u32 s64, s64, 8192
L_wqlate_28:
  s_cmp_eq_u32 s51, 0
  s_cbranch_scc1 L_notouch_29
  s_lshl_b32 s54, s48, 1
  s_add_u32 s54, s54, s50
  s_mul_i32 s54, s54, 7
  s_add_u32 s54, s54, s51
  s_sub_u32 s54, s54, 1
  s_lshl_b32 s54, s54, 3
  s_add_u32 s54, s54, s52
  s_lshl_b32 s55, s54, 10
  v_lshlrev_b32 v4, 7, v1
  v_add_u32 v5, s55, v4
  s_mov_b64 exec, 255
  s_mov_b32 s40, s16
  s_mov_b32 s41, s17
  s_mov_b32 s42, 1835008
  s_mov_b32 s43, 0x20000
  buffer_load_dword v123, v5, s[40:43], 0 offen
  s_mov_b32 s40, s18
  s_mov_b32 s41, s19
  s_mov_b32 s42, 1835008
  s_mov_b32 s43, 0x20000
  buffer_load_dword v123, v5, s[40:43], 0 offen
  s_mov_b32 s40, s20
  s_mov_b32 s41, s21
  s_mov_b32 s42, 1835008
  s_mov_b32 s43, 0x20000
  buffer_load_dword v123, v5, s[40:43], 0 offen
  s_mov_b32 s40, s12
  s_mov_b32 s41, s13
  s_mov_b32 s42, 524288
  s_mov_b32 s43, 0x20000
  s_mov_b64 exec, -1
  s_mul_i32 s55, s54, 384
  v_add_u32 v4, s55, v4
  s_mov_b64 exec, 7
  buffer_load_dword v123, v4, s[40:43], 0 offen
  s_mov_b64 exec, -1
L_notouch_29:
  s_waitcnt lgkmcnt(0)
  s_barrier
  v_readfirstlane_b32 s3, v32
  v_fma_f32 v128, v128, v24, v16
  v_fma_f32 v129, v129, v25, v17
  v_fma_f32 v130, v130, v26, v18
  v_fma_f32 v131, v131, v27, v19
  v_fma_f32 v132, v132, v28, v20
  v_fma_f32 v133, v133, v29, v21
  v_fma_f32 v134, v134, v30, v22
  v_fma_f32 v135, v135, v31, v23
  v_cvt_pk_bf16_f32 v48, v128, v129
  v_cvt_pk_bf16_f32 v49, v130, v131
  v_cvt_pk_bf16_f32 v50, v132, v133
  v_cvt_pk_bf16_f32 v51, v134, v135
  ds_write_b128 v112, v[48:51] offset:0
  v_fma_f32 v136, v136, v24, v16
  v_fma_f32 v137, v137, v25, v17
  v_fma_f32 v138, v138, v26, v18
  v_fma_f32 v139, v139, v27, v19
  v_fma_f32 v140, v140, v28, v20
  v_fma_f32 v141, v141, v29, v21
  v_fma_f32 v142, v142, v30, v22
  v_fma_f32 v143, v143, v31, v23
  v_cvt_pk_bf16_f32 v52, v136, v137
  v_cvt_pk_bf16_f32 v53, v138, v139
  v_cvt_pk_bf16_f32 v54, v140, v141
  v_cvt_pk_bf16_f32 v55, v142, v143
  ds_write_b128 v113, v[52:55] offset:1024
  v_fma_f32 v144, v144, v24, v16
  v_fma_f32 v145, v145, v25, v17
  v_fma_f32 v146, v146, v26, v18
  v_fma_f32 v147, v147, v27, v19
  v_fma_f32 v148, v148, v28, v20
  v_fma_f32 v149, v149, v29, v21
  v_fma_f32 v150, v150, v30, v22
  v_fma_f32 v151, v151, v31, v23
  v_cvt_pk_bf16_f32 v56, v144, v145
  v_cvt_pk_bf16_f32 v57, v146, v147
  v_cvt_pk_bf16_f32 v58, v148, v149
  v_cvt_pk_bf16_f32 v59, v150, v151
  ds_write_b128 v114, v[56:59] offset:2048
  v_fma_f32 v152, v152, v24, v16
  v_fma_f32 v153, v153, v25, v17
  v_fma_f32 v154, v154, v26, v18
  v_fma_f32 v155, v155, v27, v19
  v_fma_f32 v156, v156, v28, v20
  v_fma_f32 v157, v157, v29, v21
  v_fma_f32 v158, v158, v30, v22
  v_fma_f32 v159, v159, v31, v23
  v_cvt_pk_bf16_f32 v60, v152, v153
  v_cvt_pk_bf16_f32 v61, v154, v155
  v_cvt_pk_bf16_f32 v62, v156, v157
  v_cvt_pk_bf16_f32 v63, v158, v159
  ds_write_b128 v115, v[60:63] offset:3072
  v_fma_f32 v160, v160, v24, v16
  v_fma_f32 v161, v161, v25, v17
  v_fma_f32 v162, v162, v26, v18
  v_fma_f32 v163, v163, v27, v19
  v_fma_f32 v164, v164, v28, v20
  v_fma_f32 v165, v165, v29, v21
  v_fma_f32 v166, v166, v30, v22
  v_fma_f32 v167, v167, v31, v23
  v_cvt_pk_bf16_f32 v64, v160, v161
  v_cvt_pk_bf16_f32 v65, v162, v163
  v_cvt_pk_bf16_f32 v66, v164, v165
  v_cvt_pk_bf16_f32 v67, v166, v167
  ds_write_b128 v116, v[64:67] offset:4096
  v_fma_f32 v168, v168, v24, v16
  v_fma_f32 v169, v169, v25, v17
  v_fma_f32 v170, v170, v26, v18
  v_fma_f32 v171, v171, v27, v19
  v_fma_f32 v172, v172, v28, v20
  v_fma_f32 v173, v173, v29, v21
  v_fma_f32 v174, v174, v30, v22
  v_fma_f32 v175, v175, v31, v23
  v_cvt_pk_bf16_f32 v68, v168, v169
  v_cvt_pk_bf16_f32 v69, v170, v171
  v_cvt_pk_bf16_f32 v70, v172, v173
  v_cvt_pk_bf16_f32 v71, v174, v175
  ds_write_b128 v117, v[68:71] offset:5120
  v_fma_f32 v176, v176, v24, v16
  v_fma_f32 v177, v177, v25, v17
  v_fma_f32 v178, v178, v26, v18
  v_fma_f32 v179, v179, v27, v19
  v_fma_f32 v180, v180, v28, v20
  v_fma_f32 v181, v181, v29, v21
  v_fma_f32 v182, v182, v30, v22
  v_fma_f32 v183, v183, v31, v23
  v_cvt_pk_bf16_f32 v72, v176, v177
  v_cvt_pk_bf16_f32 v73, v178, v179
  v_cvt_pk_bf16_f32 v74, v180, v181
  v_cvt_pk_bf16_f32 v75, v182, v183
  ds_write_b128 v118, v[72:75] offset:6144
  v_fma_f32 v184, v184, v24, v16
  v_fma_f32 v185, v185, v25, v17
  v_fma_f32 v186, v186, v26, v18
  v_fma_f32 v187, v187, v27, v19
  v_fma_f32 v188, v188, v28, v20
  v_fma_f32 v189, v189, v29, v21
  v_fma_f32 v190, v190, v30, v22
  v_fma_f32 v191, v191, v31, v23
  v_cvt_pk_bf16_f32 v76, v184, v185
  v_cvt_pk_bf16_f32 v77, v186, v187
  v_cvt_pk_bf16_f32 v78, v188, v189
  v_cvt_pk_bf16_f32 v79, v190, v191
  ds_write_b128 v119, v[76:79] offset:7168
  s_waitcnt lgkmcnt(0)
  s_barrier
  s_cmp_lg_u32 s51, 0
  s_cbranch_scc1 L_nokv3_30
  s_cmp_ge_u32 s52, 4
  s_cbranch_scc1 L_nokv3_30w
  s_setprio 2
  v_and_b32 v2, 31, v1
  v_lshrrev_b32 v3, 5, v1
  v_and_b32 v8, 15, v1
  v_xor_b32 v8, v8, v3
  v_lshlrev_b32 v8, 4, v8
  v_lshl_add_u32 v8, v2, 10, v8
  s_lshl_b32 s54, s87, 15
  s_add_u32 s54, s54, 98304
  v_add_u32 v8, s54, v8
  v_xor_b32 v112, 0, v8
  v_xor_b32 v113, 32, v8
  v_xor_b32 v114, 64, v8
  v_xor_b32 v115, 96, v8
  v_xor_b32 v116, 128, v8
  v_xor_b32 v117, 160, v8
  v_xor_b32 v118, 192, v8
  v_xor_b32 v119, 224, v8
  v_bfe_u32 v2, v1, 4, 1
  v_bfe_u32 v3, v1, 2, 2
  v_and_b32 v4, 3, v1
  v_lshrrev_b32 v5, 5, v1
  v_lshl_add_u32 v7, v5, 3, v3
  v_lshlrev_b32 v10, 2, v2
  v_xor_b32 v11, v7, v10
  v_xor_b32 v12, 4, v11
  v_lshlrev_b32 v10, 14, v2
  v_lshl_add_u32 v10, v4, 3, v10
  v_add_u32 v10, 65536, v10
  v_lshl_add_u32 v11, v11, 5, v10
  v_lshl_add_u32 v12, v12, 5, v10
  s_bitcmp1_b32 s52, 0
  s_cbranch_scc1 L_kvV_31
  ds_read_b128 v[48:51], v112 offset:0
  ds_read_b64_tr_b16 v[64:65], v11 offset:0
  ds_read_b64_tr_b16 v[66:67], v12 offset:0
  ds_read_b128 v[52:55], v113 offset:0
  ds_read_b64_tr_b16 v[68:69], v11 offset:512
  ds_read_b64_tr_b16 v[70:71], v12 offset:512
  ds_read_b128 v[56:59], v114 offset:0
  ds_read_b64_tr_b16 v[72:73], v11 offset:1024
  ds_read_b64_tr_b16 v[74:75], v12 offset:1024
  ds_read_b128 v[60:63], v115 offset:0
  ds_read_b64_tr_b16 v[76:77], v11 offset:1536
  ds_read_b64_tr_b16 v[78:79], v12 offset:1536
  s_waitcnt lgkmcnt(9)
  v_mfma_f32_32x32x16_bf16 v[16:31], v[64:67], v[48:51], 0
  ds_read_b128 v[48:51], v116 offset:0
  ds_read_b64_tr_b16 v[64:65], v11 offset:2048
  ds_read_b64_tr_b16 v[66:67], v12 offset:2048
  s_waitcnt lgkmcnt(9)
  v_mfma_f32_32x32x16_bf16 v[16:31], v[68:71], v[52:55], v[16:31]
  ds_read_b128 v[52:55], v117 offset:0
  ds_read_b64_tr_b16 v[68:69], v11 offset:2560
  ds_read_b64_tr_b16 v[70:71], v12 offset:2560
  s_waitcnt lgkmcnt(9)
  v_mfma_f32_32x32x16_bf16 v[16:31], v[72:75], v[56:59], v[16:31]
  ds_read_b128 v[56:59], v118 offset:0
  ds_read_b64_tr_b16 v[72:73], v11 offset:3072
  ds_read_b64_tr_b16 v[74:75], v12 offset:3072
  s_waitcnt lgkmcnt(9)
  v_mfma_f32_32x32x16_bf16 v[16:31], v[76:79], v[60:63], v[16:31]
  ds_read_b128 v[60:63], v119 offset:0
  ds_read_b64_tr_b16 v[76:77], v11 offset:3584
  ds_read_b64_tr_b16 v[78:79], v12 offset:3584
  s_waitcnt lgkmcnt(9)
  v_mfma_f32_32x32x16_bf16 v[16:31], v[64:67], v[48:51], v[16:31]
  ds_read_b128 v[48:51], v112 offset:256
  ds_read_b64_tr_b16 v[64:65], v11 offset:4096
  ds_read_b64_tr_b16 v[66:67], v12 offset:4096
  s_waitcnt lgkmcnt(9)
  v_mfma_f32_32x32x16_bf16 v[16:31], v[68:71], v[52:55], v[16:31]
  ds_read_b128 v[52:55], v113 offset:256
  ds_read_b64_tr_b16 v[68:69], v11 offset:4608
  ds_read_b64_tr_b16 v[70:71], v12 offset:4608
  s_waitcnt lgkmcnt(9)
  v_mfma_f32_32x32x16_bf16 v[16:31], v[72:75], v[56:59], v[16:31]
  ds_read_b128 v[56:59], v114 offset:256
  ds_read_b64_tr_b16 v[72:73], v11 offset:5120
  ds_read_b64_tr_b16 v[74:75], v12 offset:5120
  s_waitcnt lgkmcnt(9)
  v_mfma_f32_32x32x16_bf16 v[16:31], v[76:79], v[60:63], v[16:31]
  ds_read_b128 v[60:63], v115 offset:256
  ds_read_b64_tr_b16 v[76:77], v11 offset:5632
  ds_read_b64_tr_b16 v[78:79], v12 offset:5632
  s_waitcnt lgkmcnt(9)
  v_mfma_f32_32x32x16_bf16 v[16:31], v[64:67], v[48:51], v[16:31]
  ds_read_b128 v[48:51], v116 offset:256
  ds_read_b64_tr_b16 v[64:65], v11 offset:6144
  ds_read_b64_tr_b16 v[66:67], v12 offset:6144
  s_waitcnt lgkmcnt(9)
  v_mfma_f32_32x32x16_bf16 v[16:31], v[68:71], v[52:55], v[16:31]
  ds_read_b128 v[52:55], v117 offset:256
  ds_read_b64_tr_b16 v[68:69], v11 offset:6656
  ds_read_b64_tr_b16 v[70:71], v12 offset:6656
  s_waitcnt lgkmcnt(9)
  v_mfma_f32_32x32x16_bf16 v[16:31], v[72:75], v[56:59], v[16:31]
  ds_read_b128 v[56:59], v118 offset:256
  ds_read_b64_tr_b16 v[72:73], v11 offset:7168
  ds_read_b64_tr_b16 v[74:75], v12 offset:7168
  s_waitcnt lgkmcnt(9)
  v_mfma_f32_32x32x16_bf16 v[16:31], v[76:79], v[60:63], v[16:31]
  ds_read_b128 v[60:63], v119 offset:256
  ds_read_b64_tr_b16 v[76:77], v11 offset:7680
  ds_read_b64_tr_b16 v[78:79], v12 offset:7680
  s_waitcnt lgkmcnt(9)
  v_mfma_f32_32x32x16_bf16 v[16:31], v[64:67], v[48:51], v[16:31]
  ds_read_b128 v[48:51], v112 offset:512
  ds_read_b64_tr_b16 v[64:65], v11 offset:8192
  ds_read_b64_tr_b16 v[66:67], v12 offset:8192
  s_waitcnt lgkmcnt(9)
  v_mfma_f32_32x32x16_bf16 v[16:31], v[68:71], v[52:55], v[16:31]
  ds_read_b128 v[52:55], v113 offset:512
  ds_read_b64_tr_b16 v[68:69], v11 offset:8704
  ds_read_b64_tr_b16 v[70:71], v12 offset:8704
  s_waitcnt lgkmcnt(9)
  v_mfma_f32_32x32x16_bf16 v[16:31], v[72:75], v[56:59], v[16:31]
  ds_read_b128 v[56:59], v114 offset:512
  ds_read_b64_tr_b16 v[72:73], v11 offset:9216
  ds_read_b64_tr_b16 v[74:75], v12 offset:9216
  s_waitcnt lgkmcnt(9)
  v_mfma_f32_32x32x16_bf16 v[16:31], v[76:79], v[60:63], v[16:31]
  ds_read_b128 v[60:63], v115 offset:512
  ds_read_b64_tr_b16 v[76:77], v11 offset:9728
  ds_read_b64_tr_b16 v[78:79], v12 offset:9728
  s_waitcnt lgkmcnt(9)
  v_mfma_f32_32x32x16_bf16 v[16:31], v[64:67], v[48:51], v[16:31]
  ds_read_b128 v[48:51], v116 offset:512
  ds_read_b64_tr_b16 v[64:65], v11 offset:10240
  ds_read_b64_tr_b16 v[66:67], v12 offset:10240
  s_waitcnt lgkmcnt(9)
  v_mfma_f32_32x32x16_bf16 v[16:31], v[68:71], v[52:55], v[16:31]
  ds_read_b128 v[52:55], v117 offset:512
  ds_read_b64_tr_b16 v[68:69], v11 offset:10752
  ds_read_b64_tr_b16 v[70:71], v12 offset:10752
  s_waitcnt lgkmcnt(9)
  v_mfma_f32_32x32x16_bf16 v[16:31], v[72:75], v[56:59], v[16:31]
  ds_read_b128 v[56:59], v118 offset:512
  ds_read_b64_tr_b16 v[72:73], v11 offset:11264
  ds_read_b64_tr_b16 v[74:75], v12 offset:11264
  s_waitcnt lgkmcnt(9)
  v_mfma_f32_32x32x16_bf16 v[16:31], v[76:79], v[60:63], v[16:31]
  ds_read_b128 v[60:63], v119 offset:512
  ds_read_b64_tr_b16 v[76:77], v11 offset:11776
  ds_read_b64_tr_b16 v[78:79], v12 offset:11776
  s_waitcnt lgkmcnt(9)
  v_mfma_f32_32x32x16_bf16 v[16:31], v[64:67], v[48:51], v[16:31]
  ds_read_b128 v[48:51], v112 offset:768
  ds_read_b64_tr_b16 v[64:65], v11 offset:12288
  ds_read_b64_tr_b16 v[66:67], v12 offset:12288
  s_waitcnt lgkmcnt(9)
  v_mfma_f32_32x32x16_bf16 v[16:31], v[68:71], v[52:55], v[16:31]
  ds_read_b128 v[52:55], v113 offset:768
  ds_read_b64_tr_b16 v[68:69], v11 offset:12800
  ds_read_b64_tr_b16 v[70:71], v12 offset:12800
  s_waitcnt lgkmcnt(9)
  v_mfma_f32_32x32x16_bf16 v[16:31], v[72:75], v[56:59], v[16:31]
  ds_read_b128 v[56:59], v114 offset:768
  ds_read_b64_tr_b16 v[72:73], v11 offset:13312
  ds_read_b64_tr_b16 v[74:75], v12 offset:13312
  s_waitcnt lgkmcnt(9)
  v_mfma_f32_32x32x16_bf16 v[16:31], v[76:79], v[60:63], v[16:31]
  ds_read_b128 v[60:63], v115 offset:768
  ds_read_b64_tr_b16 v[76:77], v11 offset:13824
  ds_read_b64_tr_b16 v[78:79], v12 offset:13824
  s_waitcnt lgkmcnt(9)
  v_mfma_f32_32x32x16_bf16 v[16:31], v[64:67], v[48:51], v[16:31]
  ds_read_b128 v[48:51], v116 offset:768
  ds_read_b64_tr_b16 v[64:65], v11 offset:14336
  ds_read_b64_tr_b16 v[66:67], v12 offset:14336
  s_waitcnt lgkmcnt(9)
  v_mfma_f32_32x32x16_bf16 v[16:31], v[68:71], v[52:55], v[16:31]
  ds_read_b128 v[52:55], v117 offset:768
  ds_read_b64_tr_b16 v[68:69], v11 offset:14848
  ds_read_b64_tr_b16 v[70:71], v12 offset:14848
  s_waitcnt lgkmcnt(9)
  v_mfma_f32_32x32x16_bf16 v[16:31], v[72:75], v[56:59], v[16:31]
  ds_read_b128 v[56:59], v118 offset:768
  ds_read_b64_tr_b16 v[72:73], v11 offset:15360
  ds_read_b64_tr_b16 v[74:75], v12 offset:15360
  s_waitcnt lgkmcnt(9)
  v_mfma_f32_32x32x16_bf16 v[16:31], v[76:79], v[60:63], v[16:31]
  ds_read_b128 v[60:63], v119 offset:768
  ds_read_b64_tr_b16 v[76:77], v11 offset:15872
  ds_read_b64_tr_b16 v[78:79], v12 offset:15872
  s_waitcnt lgkmcnt(9)
  v_mfma_f32_32x32x16_bf16 v[16:31], v[64:67], v[48:51], v[16:31]
  s_waitcnt lgkmcnt(6)
  v_mfma_f32_32x32x16_bf16 v[16:31], v[68:71], v[52:55], v[16:31]
  s_waitcnt lgkmcnt(3)
  v_mfma_f32_32x32x16_bf16 v[16:31], v[72:75], v[56:59], v[16:31]
  s_waitcnt lgkmcnt(0)
  v_mfma_f32_32x32x16_bf16 v[16:31], v[76:79], v[60:63], v[16:31]
  s_lshl_b32 s54, s48, 2
  s_lshl_b32 s55, s50, 1
  s_add_u32 s54, s54, s55
  s_add_u32 s54, s54, s87
  s_lshl_b32 s55, s54, 10
  s_nop 6
  v_cvt_pk_bf16_f32 v32, v16, v17
  v_cvt_pk_bf16_f32 v33, v18, v19
  v_cvt_pk_bf16_f32 v34, v20, v21
  v_cvt_pk_bf16_f32 v35, v22, v23
  s_add_u32 s55, s55, 393216
  v_lshlrev_b32 v9, 4, v1
  buffer_store_dwordx4 v[32:35], v9, s[32:35], s55 offen sc1
  s_branch L_kvend_32
L_kvV_31:
  ds_read_b128 v[48:51], v112 offset:0
  ds_read_b64_tr_b16 v[64:65], v11 offset:0
  ds_read_b64_tr_b16 v[66:67], v12 offset:0
  ds_read_b128 v[52:55], v113 offset:0
  ds_read_b64_tr_b16 v[68:69], v11 offset:512
  ds_read_b64_tr_b16 v[70:71], v12 offset:512
  ds_read_b128 v[56:59], v114 offset:0
  ds_read_b64_tr_b16 v[72:73], v11 offset:1024
  ds_read_b64_tr_b16 v[74:75], v12 offset:1024
  ds_read_b128 v[60:63], v115 offset:0
  ds_read_b64_tr_b16 v[76:77], v11 offset:1536
  ds_read_b64_tr_b16 v[78:79], v12 offset:1536
  s_waitcnt lgkmcnt(9)
  v_mfma_f32_32x32x16_bf16 v[16:31], v[48:51], v[64:67], 0
  ds_read_b128 v[48:51], v116 offset:0
  ds_read_b64_tr_b16 v[64:65], v11 offset:2048
  ds_read_b64_tr_b16 v[66:67], v12 offset:2048
  s_waitcnt lgkmcnt(9)
  v_mfma_f32_32x32x16_bf16 v[16:31], v[52:55], v[68:71], v[16:31]
  ds_read_b128 v[52:55], v117 offset:0
  ds_read_b64_tr_b16 v[68:69], v11 offset:2560
  ds_read_b64_tr_b16 v[70:71], v12 offset:2560
  s_waitcnt lgkmcnt(9)
  v_mfma_f32_32x32x16_bf16 v[16:31], v[56:59], v[72:75], v[16:31]
  ds_read_b128 v[56:59], v118 offset:0
  ds_read_b64_tr_b16 v[72:73], v11 offset:3072
  ds_read_b64_tr_b16 v[74:75], v12 offset:3072
  s_waitcnt lgkmcnt(9)
  v_mfma_f32_32x32x16_bf16 v[16:31], v[60:63], v[76:79], v[16:31]
  ds_read_b128 v[60:63], v119 offset:0
  ds_read_b64_tr_b16 v[76:77], v11 offset:3584
  ds_read_b64_tr_b16 v[78:79], v12 offset:3584
  s_waitcnt lgkmcnt(9)
  v_mfma_f32_32x32x16_bf16 v[16:31], v[48:51], v[64:67], v[16:31]
  ds_read_b128 v[48:51], v112 offset:256
  ds_read_b64_tr_b16 v[64:65], v11 offset:4096
  ds_read_b64_tr_b16 v[66:67], v12 offset:4096
  s_waitcnt lgkmcnt(9)
  v_mfma_f32_32x32x16_bf16 v[16:31], v[52:55], v[68:71], v[16:31]
  ds_read_b128 v[52:55], v113 offset:256
  ds_read_b64_tr_b16 v[68:69], v11 offset:4608
  ds_read_b64_tr_b16 v[70:71], v12 offset:4608
  s_waitcnt lgkmcnt(9)
  v_mfma_f32_32x32x16_bf16 v[16:31], v[56:59], v[72:75], v[16:31]
  ds_read_b128 v[56:59], v114 offset:256
  ds_read_b64_tr_b16 v[72:73], v11 offset:5120
  ds_read_b64_tr_b16 v[74:75], v12 offset:5120
  s_waitcnt lgkmcnt(9)
  v_mfma_f32_32x32x16_bf16 v[16:31], v[60:63], v[76:79], v[16:31]
  ds_read_b128 v[60:63], v115 offset:256
  ds_read_b64_tr_b16 v[76:77], v11 offset:5632
  ds_read_b64_tr_b16 v[78:79], v12 offset:5632
  s_waitcnt lgkmcnt(9)
  v_mfma_f32_32x32x16_bf16 v[16:31], v[48:51], v[64:67], v[16:31]
  ds_read_b128 v[48:51], v116 offset:256
  ds_read_b64_tr_b16 v[64:65], v11 offset:6144
  ds_read_b64_tr_b16 v[66:67], v12 offset:6144
  s_waitcnt lgkmcnt(9)
  v_mfma_f32_32x32x16_bf16 v[16:31], v[52:55], v[68:71], v[16:31]
  ds_read_b128 v[52:55], v117 offset:256
  ds_read_b64_tr_b16 v[68:69], v11 offset:6656
  ds_read_b64_tr_b16 v[70:71], v12 offset:6656
  s_waitcnt lgkmcnt(9)
  v_mfma_f32_32x32x16_bf16 v[16:31], v[56:59], v[72:75], v[16:31]
  ds_read_b128 v[56:59], v118 offset:256
  ds_read_b64_tr_b16 v[72:73], v11 offset:7168
  ds_read_b64_tr_b16 v[74:75], v12 offset:7168
  s_waitcnt lgkmcnt(9)
  v_mfma_f32_32x32x16_bf16 v[16:31], v[60:63], v[76:79], v[16:31]
  ds_read_b128 v[60:63], v119 offset:256
  ds_read_b64_tr_b16 v[76:77], v11 offset:7680
  ds_read_b64_tr_b16 v[78:79], v12 offset:7680
  s_waitcnt lgkmcnt(9)
  v_mfma_f32_32x32x16_bf16 v[16:31], v[48:51], v[64:67], v[16:31]
  ds_read_b128 v[48:51], v112 offset:512
  ds_read_b64_tr_b16 v[64:65], v11 offset:8192
  ds_read_b64_tr_b16 v[66:67], v12 offset:8192
  s_waitcnt lgkmcnt(9)
  v_mfma_f32_32x32x16_bf16 v[16:31], v[52:55], v[68:71], v[16:31]
  ds_read_b128 v[52:55], v113 offset:512
  ds_read_b64_tr_b16 v[68:69], v11 offset:8704
  ds_read_b64_tr_b16 v[70:71], v12 offset:8704
  s_waitcnt lgkmcnt(9)
  v_mfma_f32_32x32x16_bf16 v[16:31], v[56:59], v[72:75], v[16:31]
  ds_read_b128 v[56:59], v114 offset:512
  ds_read_b64_tr_b16 v[72:73], v11 offset:9216
  ds_read_b64_tr_b16 v[74:75], v12 offset:9216
  s_waitcnt lgkmcnt(9)
  v_mfma_f32_32x32x16_bf16 v[16:31], v[60:63], v[76:79], v[16:31]
  ds_read_b128 v[60:63], v115 offset:512
  ds_read_b64_tr_b16 v[76:77], v11 offset:9728
  ds_read_b64_tr_b16 v[78:79], v12 offset:9728
  s_waitcnt lgkmcnt(9)
  v_mfma_f32_32x32x16_bf16 v[16:31], v[48:51], v[64:67], v[16:31]
  ds_read_b128 v[48:51], v116 offset:512
  ds_read_b64_tr_b16 v[64:65], v11 offset:10240
  ds_read_b64_tr_b16 v[66:67], v12 offset:10240
  s_waitcnt lgkmcnt(9)
  v_mfma_f32_32x32x16_bf16 v[16:31], v[52:55], v[68:71], v[16:31]
  ds_read_b128 v[52:55], v117 offset:512
  ds_read_b64_tr_b16 v[68:69], v11 offset:10752
  ds_read_b64_tr_b16 v[70:71], v12 offset:10752
  s_waitcnt lgkmcnt(9)
  v_mfma_f32_32x32x16_bf16 v[16:31], v[56:59], v[72:75], v[16:31]
  ds_read_b128 v[56:59], v118 offset:512
  ds_read_b64_tr_b16 v[72:73], v11 offset:11264
  ds_read_b64_tr_b16 v[74:75], v12 offset:11264
  s_waitcnt lgkmcnt(9)
  v_mfma_f32_32x32x16_bf16 v[16:31], v[60:63], v[76:79], v[16:31]
  ds_read_b128 v[60:63], v119 offset:512
  ds_read_b64_tr_b16 v[76:77], v11 offset:11776
  ds_read_b64_tr_b16 v[78:79], v12 offset:11776
  s_waitcnt lgkmcnt(9)
  v_mfma_f32_32x32x16_bf16 v[16:31], v[48:51], v[64:67], v[16:31]
  ds_read_b128 v[48:51], v112 offset:768
  ds_read_b64_tr_b16 v[64:65], v11 offset:12288
  ds_read_b64_tr_b16 v[66:67], v12 offset:12288
  s_waitcnt lgkmcnt(9)
  v_mfma_f32_32x32x16_bf16 v[16:31], v[52:55], v[68:71], v[16:31]
  ds_read_b128 v[52:55], v113 offset:768
  ds_read_b64_tr_b16 v[68:69], v11 offset:12800
  ds_read_b64_tr_b16 v[70:71], v12 offset:12800
  s_waitcnt lgkmcnt(9)
  v_mfma_f32_32x32x16_bf16 v[16:31], v[56:59], v[72:75], v[16:31]
  ds_read_b128 v[56:59], v114 offset:768
  ds_read_b64_tr_b16 v[72:73], v11 offset:13312
  ds_read_b64_tr_b16 v[74:75], v12 offset:13312
  s_waitcnt lgkmcnt(9)
  v_mfma_f32_32x32x16_bf16 v[16:31], v[60:63], v[76:79], v[16:31]
  ds_read_b128 v[60:63], v115 offset:768
  ds_read_b64_tr_b16 v[76:77], v11 offset:13824
  ds_read_b64_tr_b16 v[78:79], v12 offset:13824
  s_waitcnt lgkmcnt(9)
  v_mfma_f32_32x32x16_bf16 v[16:31], v[48:51], v[64:67], v[16:31]
  ds_read_b128 v[48:51], v116 offset:768
  ds_read_b64_tr_b16 v[64:65], v11 offset:14336
  ds_read_b64_tr_b16 v[66:67], v12 offset:14336
  s_waitcnt lgkmcnt(9)
  v_mfma_f32_32x32x16_bf16 v[16:31], v[52:55], v[68:71], v[16:31]
  ds_read_b128 v[52:55], v117 offset:768
  ds_read_b64_tr_b16 v[68:69], v11 offset:14848
  ds_read_b64_tr_b16 v[70:71], v12 offset:14848
  s_waitcnt lgkmcnt(9)
  v_mfma_f32_32x32x16_bf16 v[16:31], v[56:59], v[72:75], v[16:31]
  ds_read_b128 v[56:59], v118 offset:768
  ds_read_b64_tr_b16 v[72:73], v11 offset:15360
  ds_read_b64_tr_b16 v[74:75], v12 offset:15360
  s_waitcnt lgkmcnt(9)
  v_mfma_f32_32x32x16_bf16 v[16:31], v[60:63], v[76:79], v[16:31]
  ds_read_b128 v[60:63], v119 offset:768
  ds_read_b64_tr_b16 v[76:77], v11 offset:15872
  ds_read_b64_tr_b16 v[78:79], v12 offset:15872
  s_waitcnt lgkmcnt(9)
  v_mfma_f32_32x32x16_bf16 v[16:31], v[48:51], v[64:67], v[16:31]
  s_waitcnt lgkmcnt(6)
  v_mfma_f32_32x32x16_bf16 v[16:31], v[52:55], v[68:71], v[16:31]
  s_waitcnt lgkmcnt(3)
  v_mfma_f32_32x32x16_bf16 v[16:31], v[56:59], v[72:75], v[16:31]
  s_waitcnt lgkmcnt(0)
  v_mfma_f32_32x32x16_bf16 v[16:31], v[60:63], v[76:79], v[16:31]
  s_lshl_b32 s54, s48, 2
  s_lshl_b32 s55, s50, 1
  s_add_u32 s54, s54, s55
  s_add_u32 s54, s54, s87
  s_lshl_b32 s55, s54, 10
  s_nop 6
  v_cvt_pk_bf16_f32 v32, v16, v17
  v_cvt_pk_bf16_f32 v33, v18, v19
  v_cvt_pk_bf16_f32 v34, v20, v21
  v_cvt_pk_bf16_f32 v35, v22, v23
  v_cvt_pk_bf16_f32 v36, v24, v25
  v_cvt_pk_bf16_f32 v37, v26, v27
  v_cvt_pk_bf16_f32 v38, v28, v29
  v_cvt_pk_bf16_f32 v39, v30, v31
  s_add_u32 s55, s55, 458752
  v_and_b32 v9, 15, v1
  v_lshrrev_b32 v10, 5, v1
  v_lshlrev_b32 v9, 4, v9
  v_lshl_add_u32 v9, v10, 8, v9
  s_mov_b32 exec_lo, 0xffff0000
  s_mov_b32 exec_hi, 0xffff0000
  buffer_store_dwordx4 v[32:35], v9, s[32:35], s55 offen sc1
  buffer_store_dwordx4 v[36:39], v9, s[32:35], s55 offen offset:512 sc1
  s_mov_b64 exec, -1
L_kvend_32:
  s_lshl_b32 s54, s54, 3
  s_lshl_b32 s55, s95, 2
  s_add_u32 s54, s54, s55
  s_add_u32 s93, s54, 65536
  s_setprio 0
L_nokv3_30w:
L_nokv3_30:
  s_cmp_eq_u32 s51, 0
  s_cbranch_scc1 L_qwk_33
  s_waitcnt vmcnt(4)
  s_branch L_qwd_34
L_qwk_33:
  s_cmp_ge_u32 s52, 4
  s_cbranch_scc1 L_qwk_33z
  s_bitcmp1_b32 s52, 0
  s_cbranch_scc1 L_qwk_33v
  s_waitcnt vmcnt(1)
  s_branch L_qwd_34
L_qwk_33v:
  s_waitcnt vmcnt(2)
  s_branch L_qwd_34
L_qwk_33z:
  s_waitcnt vmcnt(0)
L_qwd_34:
  s_barrier
  v_and_b32 v2, 31, v1
  v_lshrrev_b32 v3, 5, v1
  v_and_b32 v8, 15, v1
  v_xor_b32 v8, v8, v3
  v_lshlrev_b32 v8, 4, v8
  v_lshl_add_u32 v8, v2, 10, v8
  s_lshl_b32 s54, s95, 15
  s_add_u32 s54, s54, 98304
  v_add_u32 v8, s54, v8
  s_lshr_b32 s54, s52, 2
  s_lshl_b32 s54, s54, 9
  v_add_u32 v8, s54, v8
  v_xor_b32 v112, 0, v8
  v_xor_b32 v113, 32, v8
  v_xor_b32 v114, 64, v8
  v_xor_b32 v115, 96, v8
  v_xor_b32 v116, 128, v8
  v_xor_b32 v117, 160, v8
  v_xor_b32 v118, 192, v8
  v_xor_b32 v119, 224, v8
  v_bfe_u32 v2, v1, 4, 1
  v_bfe_u32 v3, v1, 2, 2
  v_and_b32 v4, 3, v1
  v_lshrrev_b32 v5, 5, v1
  v_lshl_add_u32 v7, v5, 3, v3
  v_lshlrev_b32 v6, 1, v2
  v_lshrrev_b32 v5, 1, v4
  v_add_u32 v6, v6, v5
  v_lshrrev_b32 v5, 1, v3
  v_lshlrev_b32 v5, 2, v5
  v_xor_b32 v6, v6, v5
  v_lshlrev_b32 v6, 4, v6
  v_and_b32 v5, 1, v4
  v_lshl_add_u32 v6, v5, 3, v6
  v_lshl_add_u32 v8, v7, 7, v6
  s_bfe_u32 s54, s52, 0x10001
  s_lshl_b32 s54, s54, 6
  v_xor_b32 v8, s54, v8
  s_lshr_b32 s54, s52, 2
  s_lshl_b32 s54, s54, 15
  v_add_u32 v8, s54, v8
  ds_read_b128 v[48:51], v112 offset:0
  ds_read_b64_tr_b16 v[64:65], v8 offset:0
  ds_read_b64_tr_b16 v[66:67], v8 offset:512
  ds_read_b128 v[52:55], v113 offset:0
  ds_read_b64_tr_b16 v[68:69], v8 offset:2048
  ds_read_b64_tr_b16 v[70:71], v8 offset:2560
  ds_read_b128 v[56:59], v114 offset:0
  ds_read_b64_tr_b16 v[72:73], v8 offset:4096
  ds_read_b64_tr_b16 v[74:75], v8 offset:4608
  ds_read_b128 v[60:63], v115 offset:0
  ds_read_b64_tr_b16 v[76:77], v8 offset:6144
  ds_read_b64_tr_b16 v[78:79], v8 offset:6656
  s_waitcnt lgkmcnt(9)
  v_mfma_f32_32x32x16_bf16 v[16:31], v[64:67], v[48:51], 0
  ds_read_b128 v[48:51], v116 offset:0
  ds_read_b64_tr_b16 v[64:65], v8 offset:8192
  ds_read_b64_tr_b16 v[66:67], v8 offset:8704
  s_waitcnt lgkmcnt(9)
  v_mfma_f32_32x32x16_bf16 v[16:31], v[68:71], v[52:55], v[16:31]
  ds_read_b128 v[52:55], v117 offset:0
  ds_read_b64_tr_b16 v[68:69], v8 offset:10240
  ds_read_b64_tr_b16 v[70:71], v8 offset:10752
  s_waitcnt lgkmcnt(9)
  v_mfma_f32_32x32x16_bf16 v[16:31], v[72:75], v[56:59], v[16:31]
  ds_read_b128 v[56:59], v118 offset:0
  ds_read_b64_tr_b16 v[72:73], v8 offset:12288
  ds_read_b64_tr_b16 v[74:75], v8 offset:12800
  s_waitcnt lgkmcnt(9)
  v_mfma_f32_32x32x16_bf16 v[16:31], v[76:79], v[60:63], v[16:31]
  ds_read_b128 v[60:63], v119 offset:0
  ds_read_b64_tr_b16 v[76:77], v8 offset:14336
  ds_read_b64_tr_b16 v[78:79], v8 offset:14848
  s_waitcnt lgkmcnt(9)
  v_mfma_f32_32x32x16_bf16 v[16:31], v[64:67], v[48:51], v[16:31]
  ds_read_b128 v[48:51], v112 offset:256
  ds_read_b64_tr_b16 v[64:65], v8 offset:16384
  ds_read_b64_tr_b16 v[66:67], v8 offset:16896
  s_waitcnt lgkmcnt(9)
  v_mfma_f32_32x32x16_bf16 v[16:31], v[68:71], v[52:55], v[16:31]
  ds_read_b128 v[52:55], v113 offset:256
  ds_read_b64_tr_b16 v[68:69], v8 offset:18432
  ds_read_b64_tr_b16 v[70:71], v8 offset:18944
  s_waitcnt lgkmcnt(9)
  v_mfma_f32_32x32x16_bf16 v[16:31], v[72:75], v[56:59], v[16:31]
  ds_read_b128 v[56:59], v114 offset:256
  ds_read_b64_tr_b16 v[72:73], v8 offset:20480
  ds_read_b64_tr_b16 v[74:75], v8 offset:20992
  s_waitcnt lgkmcnt(9)
  v_mfma_f32_32x32x16_bf16 v[16:31], v[76:79], v[60:63], v[16:31]
  ds_read_b128 v[60:63], v115 offset:256
  ds_read_b64_tr_b16 v[76:77], v8 offset:22528
  ds_read_b64_tr_b16 v[78:79], v8 offset:23040
  s_waitcnt lgkmcnt(9)
  v_mfma_f32_32x32x16_bf16 v[16:31], v[64:67], v[48:51], v[16:31]
  ds_read_b128 v[48:51], v116 offset:256
  ds_read_b64_tr_b16 v[64:65], v8 offset:24576
  ds_read_b64_tr_b16 v[66:67], v8 offset:25088
  s_waitcnt lgkmcnt(9)
  v_mfma_f32_32x32x16_bf16 v[16:31], v[68:71], v[52:55], v[16:31]
  ds_read_b128 v[52:55], v117 offset:256
  ds_read_b64_tr_b16 v[68:69], v8 offset:26624
  ds_read_b64_tr_b16 v[70:71], v8 offset:27136
  s_waitcnt lgkmcnt(9)
  v_mfma_f32_32x32x16_bf16 v[16:31], v[72:75], v[56:59], v[16:31]
  ds_read_b128 v[56:59], v118 offset:256
  ds_read_b64_tr_b16 v[72:73], v8 offset:28672
  ds_read_b64_tr_b16 v[74:75], v8 offset:29184
  s_waitcnt lgkmcnt(9)
  v_mfma_f32_32x32x16_bf16 v[16:31], v[76:79], v[60:63], v[16:31]
  ds_read_b128 v[60:63], v119 offset:256
  ds_read_b64_tr_b16 v[76:77], v8 offset:30720
  ds_read_b64_tr_b16 v[78:79], v8 offset:31232
  s_waitcnt lgkmcnt(9)
  v_mfma_f32_32x32x16_bf16 v[16:31], v[64:67], v[48:51], v[16:31]
  s_waitcnt lgkmcnt(6)
  v_mfma_f32_32x32x16_bf16 v[16:31], v[68:71], v[52:55], v[16:31]
  s_waitcnt lgkmcnt(3)
  v_mfma_f32_32x32x16_bf16 v[16:31], v[72:75], v[56:59], v[16:31]
  s_waitcnt lgkmcnt(0)
  v_mfma_f32_32x32x16_bf16 v[16:31], v[76:79], v[60:63], v[16:31]
  s_cmp_lg_u32 s51, 0
  s_cbranch_scc1 L_nokvf_35
  s_cmp_ge_u32 s52, 4
  s_cbranch_scc1 L_nokvf_35
  v_mul_u32_u24 v9, 1024, v1
  v_add_u32 v9, s93, v9
  v_mov_b32 v10, s53
  s_waitcnt vmcnt(0)
  s_mov_b64 exec, 0xff
  buffer_store_dword v10, v9, s[32:35], 0 offen sc1
  s_mov_b64 exec, -1
L_nokvf_35:
  s_barrier
  s_lshl_b32 s54, s52, 12
  v_lshlrev_b32 v9, 4, v1
  v_add_u32 v10, s54, v9
  s_xor_b32 s54, s52, 4
  s_lshl_b32 s54, s54, 12
  v_add_u32 v11, s54, v9
  s_nop 2
  ds_write_b128 v10, v[16:19] offset:0
  ds_write_b128 v10, v[20:23] offset:1024
  ds_write_b128 v10, v[24:27] offset:2048
  ds_write_b128 v10, v[28:31] offset:3072
  s_waitcnt lgkmcnt(0)
  s_barrier
  ds_read_b128 v[32:35], v11 offset:0
  ds_read_b128 v[36:39], v11 offset:1024
  ds_read_b128 v[40:43], v11 offset:2048
  ds_read_b128 v[44:47], v11 offset:3072
  s_mov_b32 s54, 0x3eb8aa3b
  s_waitcnt lgkmcnt(0)
  v_add_f32 v16, v16, v32
  v_add_f32 v17, v17, v33
  v_add_f32 v18, v18, v34
  v_add_f32 v19, v19, v35
  v_add_f32 v20, v20, v36
  v_add_f32 v21, v21, v37
  v_add_f32 v22, v22, v38
  v_add_f32 v23, v23, v39
  v_add_f32 v24, v24, v40
  v_add_f32 v25, v25, v41
  v_add_f32 v26, v26, v42
  v_add_f32 v27, v27, v43
  v_add_f32 v28, v28, v44
  v_add_f32 v29, v29, v45
  v_add_f32 v30, v30, v46
  v_add_f32 v31, v31, v47
  v_mul_f32 v16, s54, v16
  v_mul_f32 v17, s54, v17
  v_mul_f32 v18, s54, v18
  v_mul_f32 v19, s54, v19
  v_mul_f32 v20, s54, v20
  v_mul_f32 v21, s54, v21
  v_mul_f32 v22, s54, v22
  v_mul_f32 v23, s54, v23
  v_mul_f32 v24, s54, v24
  v_mul_f32 v25, s54, v25
  v_mul_f32 v26, s54, v26
  v_mul_f32 v27, s54, v27
  v_mul_f32 v28, s54, v28
  v_mul_f32 v29, s54, v29
  v_mul_f32 v30, s54, v30
  v_mul_f32 v31, s54, v31
  v_cvt_pk_bf16_f32 v8, v16, v17
  v_cvt_pk_bf16_f32 v9, v18, v19
  v_cvt_pk_bf16_f32 v10, v20, v21
  v_cvt_pk_bf16_f32 v11, v22, v23
  v_cvt_pk_bf16_f32 v12, v24, v25
  v_cvt_pk_bf16_f32 v13, v26, v27
  v_cvt_pk_bf16_f32 v14, v28, v29
  v_cvt_pk_bf16_f32 v15, v30, v31
  s_lshr_b32 s54, s52, 2
  s_lshl_b32 s54, s54, 15
  v_lshlrev_b32 v2, 4, v1
  v_add_u32 v112, s54, v2
  v_and_b32 v2, 15, v1
  v_lshrrev_b32 v3, 5, v1
  v_lshlrev_b32 v2, 4, v2
  v_lshl_add_u32 v2, v3, 8, v2
  s_add_u32 s54, s54, 65536
  v_add_u32 v113, s54, v2
  v_bfe_u32 v2, v1, 4, 1
  v_bfe_u32 v3, v1, 2, 2
  v_and_b32 v4, 3, v1
  v_lshrrev_b32 v5, 5, v1
  v_xor_b32 v5, v5, v2
  v_lshl_add_u32 v5, v5, 2, v3
  v_lshlrev_b32 v5, 5, v5
  v_lshl_add_u32 v5, v4, 3, v5
  v_lshl_add_u32 v5, v2, 10, v5
  s_lshl_b32 s70, s52, 12
  s_add_u32 s70, s70, 131072
  v_add_u32 v114, s70, v5
  v_lshrrev_b32 v2, 1, v1
  v_and_b32 v3, 1, v1
  v_lshlrev_b32 v3, 4, v3
  s_lshl_b32 s54, s94, 8
  s_lshl_b32 s55, s52, 5
  s_add_u32 s54, s54, s55
  v_add_u32 v3, s54, v3
  v_mul_u32_u24 v4, 3584, v2
  v_add_u32 v115, v4, v3
  v_xor_b32 v2, 4, v2
  v_mul_u32_u24 v4, 3584, v2
  v_add_u32 v116, v4, v3
  s_mov_b32 s71, 0
  s_mov_b32 s36, s16
  s_mov_b32 s37, s17
  s_mov_b32 s38, 1835008
  s_mov_b32 s39, 0x20000
  s_mov_b32 s40, s18
  s_mov_b32 s41, s19
  s_mov_b32 s42, 1835008
  s_mov_b32 s43, 0x20000
  v_mov_b32 v96, 0
  v_mov_b32 v97, 0
  v_mov_b32 v98, 0
  v_mov_b32 v99, 0
  v_mov_b32 v100, 0
  v_mov_b32 v101, 0
  v_mov_b32 v102, 0
  v_mov_b32 v103, 0
  v_mov_b32 v104, 0
  v_mov_b32 v105, 0
  v_mov_b32 v106, 0
  v_mov_b32 v107, 0
  v_mov_b32 v108, 0
  v_mov_b32 v109, 0
  v_mov_b32 v110, 0
  v_mov_b32 v111, 0
  s_mov_b32 exec_lo, 0x10000
  s_mov_b32 exec_hi, 0x10000
  v_mov_b32 v96, 0x3f803f80
  v_mov_b32 v97, 0x3f803f80
  v_mov_b32 v98, 0x3f803f80
  v_mov_b32 v99, 0x3f803f80
  v_mov_b32 v100, 0x3f803f80
  v_mov_b32 v101, 0x3f803f80
  v_mov_b32 v102, 0x3f803f80
  v_mov_b32 v103, 0x3f803f80
  v_mov_b32 v104, 0x3f803f80
  v_mov_b32 v105, 0x3f803f80
  v_mov_b32 v106, 0x3f803f80
  v_mov_b32 v107, 0x3f803f80
  v_mov_b32 v108, 0x3f803f80
  v_mov_b32 v109, 0x3f803f80
  v_mov_b32 v110, 0x3f803f80
  v_mov_b32 v111, 0x3f803f80
  s_mov_b64 exec, -1
  v_mov_b32 v48, 0
  v_mov_b32 v49, 0
  v_mov_b32 v50, 0
  v_mov_b32 v51, 0
  v_mov_b32 v52, 0
  v_mov_b32 v53, 0
  v_mov_b32 v54, 0
  v_mov_b32 v55, 0
  v_mov_b32 v56, 0
  v_mov_b32 v57, 0
  v_mov_b32 v58, 0
  v_mov_b32 v59, 0
  v_mov_b32 v60, 0
  v_mov_b32 v61, 0
  v_mov_b32 v62, 0
  v_mov_b32 v63, 0
  v_mov_b32 v64, 0
  v_mov_b32 v65, 0
  v_mov_b32 v66, 0
  v_mov_b32 v67, 0
  v_mov_b32 v68, 0
  v_mov_b32 v69, 0
  v_mov_b32 v70, 0
  v_mov_b32 v71, 0
  v_mov_b32 v72, 0
  v_mov_b32 v73, 0
  v_mov_b32 v74, 0
  v_mov_b32 v75, 0
  v_mov_b32 v76, 0
  v_mov_b32 v77, 0
  v_mov_b32 v78, 0
  v_mov_b32 v79, 0
  s_cmp_lg_u32 s52, 0
  s_cbranch_scc1 L_kvpollskip_36
  s_mul_i32 s54, s90, 1024
  s_add_u32 s54, s54, 65536
  v_lshlrev_b32 v2, 3, v1
  v_add_u32 v2, s54, v2
  s_mov_b32 s86, 400000
L_poll_37:
  buffer_load_dwordx2 v[4:5], v2, s[32:35], 0 offen sc1
  s_waitcnt vmcnt(0)
  v_cmp_ne_u32 vcc, s53, v4
  v_cmp_ne_u32 s[96:97], s53, v5
  s_or_b64 vcc, vcc, s[96:97]
  s_sub_u32 s86, s86, 1
  s_cmp_eq_u32 s86, 0
  s_cbranch_scc1 L_pollout_38
  s_cbranch_vccnz L_poll_37
L_pollout_38:
L_kvpollskip_36:
  s_barrier
  v_lshlrev_b32 v2, 4, v1
  s_lshl_b32 s54, s52, 10
  s_add_u32 s55, s54, 393216
  s_mov_b32 s80, s54
  s_mov_b32 s81, s55
  v_mov_b32 v118, v2
  s_add_u32 m0, s80, 0
  s_add_u32 s56, s81, 0
  buffer_load_dwordx4 v118, s[32:35], s56 offen sc1 lds
  s_add_u32 m0, s80, 65536
  s_add_u32 s56, s81, 65536
  buffer_load_dwordx4 v118, s[32:35], s56 offen sc1 lds
  s_add_u32 m0, s80, 32768
  s_add_u32 s56, s81, 32768
  buffer_load_dwordx4 v118, s[32:35], s56 offen sc1 lds
  s_add_u32 m0, s80, 98304
  s_add_u32 s56, s81, 98304
  buffer_load_dwordx4 v118, s[32:35], s56 offen sc1 lds
  s_add_u32 m0, s70, 0
  s_nop 0
  buffer_load_dwordx4 v115, s[36:39], s71 offen lds
  s_add_u32 m0, s70, 1024
  s_nop 0
  buffer_load_dwordx4 v116, s[40:43], s71 offen lds
  s_add_u32 s71, s71, 114688
  s_mov_b32 s72, 0xffff
  s_mov_b32 s73, 0xffff
  s_lshl_b32 s54, s48, 2
  s_lshl_b32 s55, s50, 1
  s_add_u32 s54, s54, s55
  s_add_u32 s54, s54, s95
  s_lshl_b32 s54, s54, 5
  s_lshl_b32 s55, s51, 2
  s_add_u32 s54, s54, s55
  s_and_b32 s55, s52, 2
  s_add_u32 s56, s54, s55
  s_lshr_b32 s55, s52, 2
  s_add_u32 s56, s56, s55
  s_lshl_b32 s56, s56, 10
  s_add_u32 s82, s56, 1048576
  s_add_u32 s54, s54, s87
  s_lshl_b32 s54, s54, 10
  s_add_u32 s83, s54, 3145728
  s_mul_i32 s54, s48, 458752
  s_lshl_b32 s55, s94, 3
  s_add_u32 s55, s55, s52
  s_lshl_b32 s55, s55, 10
  s_add_u32 s54, s54, s55
  s_add_u32 s84, s54, 5242880
  v_lshlrev_b32 v119, 7, v1
  s_waitcnt vmcnt(2)
  s_barrier
  ds_read_b128 v[88:91], v112 offset:0
  s_mov_b64 exec, s[72:73]
  ds_read_b128 v[96:99], v113 offset:0
  ds_read_b128 v[100:103], v113 offset:512
  s_mov_b64 exec, -1
  s_waitcnt lgkmcnt(0)
  v_mfma_f32_32x32x16_bf16 v[16:31], v[88:91], v[8:11], 0
.p2align 6
  s_nop 0
  s_setprio 3
  s_nop 9
  v_exp_f32 v16, v16
  s_add_u32 m0, s70, 2048
  v_exp_f32 v17, v17
  buffer_load_dwordx4 v115, s[36:39], s71 offen lds
  v_exp_f32 v18, v18
  s_add_u32 m0, s70, 3072
  v_exp_f32 v19, v19
  buffer_load_dwordx4 v116, s[40:43], s71 offen lds
  s_add_u32 s71, s71, 114688
  s_waitcnt vmcnt(2)
  ds_read_b64_tr_b16 v[128:129], v114 offset:0
  ds_read_b64_tr_b16 v[130:131], v114 offset:256
  v_exp_f32 v20, v20
  ds_read_b128 v[92:95], v112 offset:1024
  s_mov_b64 exec, s[72:73]
  ds_read_b128 v[104:107], v113 offset:1024
  ds_read_b128 v[108:111], v113 offset:1536
  s_mov_b64 exec, -1
  v_exp_f32 v21, v21
  v_mfma_f32_32x32x16_bf16 v[32:47], v[88:91], v[12:15], 0
  v_exp_f32 v22, v22
  v_exp_f32 v23, v23
  v_cvt_pk_bf16_f32 v80, v16, v17
  v_cvt_pk_bf16_f32 v81, v18, v19
  v_cvt_pk_bf16_f32 v82, v20, v21
  v_cvt_pk_bf16_f32 v83, v22, v23
  v_exp_f32 v24, v24
  v_exp_f32 v25, v25
  v_mfma_f32_32x32x16_bf16 v[48:63], v[96:99], v[80:83], v[48:63]
  v_exp_f32 v26, v26
  v_exp_f32 v27, v27
  s_add_u32 m0, s80, 8192
  s_add_u32 s56, s81, 8192
  v_exp_f32 v28, v28
  buffer_load_dwordx4 v118, s[32:35], s56 offen sc1 lds
  v_exp_f32 v29, v29
  v_exp_f32 v30, v30
  v_exp_f32 v31, v31
  v_cvt_pk_bf16_f32 v84, v24, v25
  v_cvt_pk_bf16_f32 v85, v26, v27
  v_cvt_pk_bf16_f32 v86, v28, v29
  v_cvt_pk_bf16_f32 v87, v30, v31
  v_exp_f32 v32, v32
  v_exp_f32 v33, v33
  v_mfma_f32_32x32x16_bf16 v[48:63], v[100:103], v[84:87], v[48:63]
  v_exp_f32 v34, v34
  v_exp_f32 v35, v35
  v_exp_f32 v36, v36
  v_exp_f32 v37, v37
  s_waitcnt lgkmcnt(0)
  v_mfma_f32_32x32x16_bf16 v[16:31], v[92:95], v[8:11], 0
  v_exp_f32 v38, v38
  v_exp_f32 v39, v39
  v_cvt_pk_bf16_f32 v80, v32, v33
  v_cvt_pk_bf16_f32 v81, v34, v35
  v_cvt_pk_bf16_f32 v82, v36, v37
  v_cvt_pk_bf16_f32 v83, v38, v39
  v_exp_f32 v40, v40
  v_exp_f32 v41, v41
  v_mfma_f32_32x32x16_bf16 v[64:79], v[96:99], v[80:83], v[64:79]
  v_exp_f32 v42, v42
  v_exp_f32 v43, v43
  s_add_u32 m0, s80, 73728
  s_add_u32 s56, s81, 73728
  v_exp_f32 v44, v44
  buffer_load_dwordx4 v118, s[32:35], s56 offen sc1 lds
  v_exp_f32 v45, v45
  v_exp_f32 v46, v46
  v_exp_f32 v47, v47
  v_cvt_pk_bf16_f32 v84, v40, v41
  v_cvt_pk_bf16_f32 v85, v42, v43
  v_cvt_pk_bf16_f32 v86, v44, v45
  v_cvt_pk_bf16_f32 v87, v46, v47
  v_exp_f32 v16, v16
  v_exp_f32 v17, v17
  v_mfma_f32_32x32x16_bf16 v[64:79], v[100:103], v[84:87], v[64:79]
  v_exp_f32 v18, v18
  v_exp_f32 v19, v19
  ds_read_b64_tr_b16 v[132:133], v114 offset:512
  ds_read_b64_tr_b16 v[134:135], v114 offset:768
  v_exp_f32 v20, v20
  ds_read_b128 v[88:91], v112 offset:2048
  s_mov_b64 exec, s[72:73]
  ds_read_b128 v[96:99], v113 offset:2048
  ds_read_b128 v[100:103], v113 offset:2560
  s_mov_b64 exec, -1
  v_exp_f32 v21, v21
  v_mfma_f32_32x32x16_bf16 v[32:47], v[92:95], v[12:15], 0
  v_exp_f32 v22, v22
  v_exp_f32 v23, v23
  v_cvt_pk_bf16_f32 v80, v16, v17
  v_cvt_pk_bf16_f32 v81, v18, v19
  v_cvt_pk_bf16_f32 v82, v20, v21
  v_cvt_pk_bf16_f32 v83, v22, v23
  v_exp_f32 v24, v24
  v_exp_f32 v25, v25
  v_mfma_f32_32x32x16_bf16 v[48:63], v[104:107], v[80:83], v[48:63]
  v_exp_f32 v26, v26
  v_exp_f32 v27, v27
  s_add_u32 m0, s80, 40960
  s_add_u32 s56, s81, 40960
  v_exp_f32 v28, v28
  buffer_load_dwordx4 v118, s[32:35], s56 offen sc1 lds
  v_exp_f32 v29, v29
  v_exp_f32 v30, v30
  v_exp_f32 v31, v31
  v_cvt_pk_bf16_f32 v84, v24, v25
  v_cvt_pk_bf16_f32 v85, v26, v27
  v_cvt_pk_bf16_f32 v86, v28, v29
  v_cvt_pk_bf16_f32 v87, v30, v31
  v_exp_f32 v32, v32
  v_exp_f32 v33, v33
  v_mfma_f32_32x32x16_bf16 v[48:63], v[108:111], v[84:87], v[48:63]
  v_exp_f32 v34, v34
  v_exp_f32 v35, v35
  v_exp_f32 v36, v36
  v_exp_f32 v37, v37
  s_waitcnt lgkmcnt(0)
  v_mfma_f32_32x32x16_bf16 v[16:31], v[88:91], v[8:11], 0
  v_exp_f32 v38, v38
  v_exp_f32 v39, v39
  v_cvt_pk_bf16_f32 v80, v32, v33
  v_cvt_pk_bf16_f32 v81, v34, v35
  v_cvt_pk_bf16_f32 v82, v36, v37
  v_cvt_pk_bf16_f32 v83, v38, v39
  v_exp_f32 v40, v40
  v_exp_f32 v41, v41
  v_mfma_f32_32x32x16_bf16 v[64:79], v[104:107], v[80:83], v[64:79]
  v_exp_f32 v42, v42
  v_exp_f32 v43, v43
  s_add_u32 m0, s80, 106496
  s_add_u32 s56, s81, 106496
  v_exp_f32 v44, v44
  buffer_load_dwordx4 v118, s[32:35], s56 offen sc1 lds
  v_exp_f32 v45, v45
  v_exp_f32 v46, v46
  v_exp_f32 v47, v47
  v_cvt_pk_bf16_f32 v84, v40, v41
  v_cvt_pk_bf16_f32 v85, v42, v43
  v_cvt_pk_bf16_f32 v86, v44, v45
  v_cvt_pk_bf16_f32 v87, v46, v47
  v_exp_f32 v16, v16
  s_add_u32 m0, s70, 0
  v_exp_f32 v17, v17
  v_mfma_f32_32x32x16_bf16 v[64:79], v[108:111], v[84:87], v[64:79]
  buffer_load_dwordx4 v115, s[36:39], s71 offen lds
  v_exp_f32 v18, v18
  s_add_u32 m0, s70, 1024
  v_exp_f32 v19, v19
  buffer_load_dwordx4 v116, s[40:43], s71 offen lds
  s_add_u32 s71, s71, 114688
  s_waitcnt vmcnt(6)
  ds_read_b64_tr_b16 v[136:137], v114 offset:2048
  ds_read_b64_tr_b16 v[138:139], v114 offset:2304
  v_exp_f32 v20, v20
  ds_read_b128 v[92:95], v112 offset:3072
  s_mov_b64 exec, s[72:73]
  ds_read_b128 v[104:107], v113 offset:3072
  ds_read_b128 v[108:111], v113 offset:3584
  s_mov_b64 exec, -1
  v_exp_f32 v21, v21
  v_mfma_f32_32x32x16_bf16 v[32:47], v[88:91], v[12:15], 0
  v_exp_f32 v22, v22
  v_exp_f32 v23, v23
  v_cvt_pk_bf16_f32 v80, v16, v17
  v_cvt_pk_bf16_f32 v81, v18, v19
  v_cvt_pk_bf16_f32 v82, v20, v21
  v_cvt_pk_bf16_f32 v83, v22, v23
  v_exp_f32 v24, v24
  v_exp_f32 v25, v25
  v_mfma_f32_32x32x16_bf16 v[48:63], v[96:99], v[80:83], v[48:63]
  v_exp_f32 v26, v26
  v_exp_f32 v27, v27
  s_add_u32 m0, s80, 16384
  s_add_u32 s56, s81, 16384
  v_exp_f32 v28, v28
  buffer_load_dwordx4 v118, s[32:35], s56 offen sc1 lds
  v_exp_f32 v29, v29
  v_exp_f32 v30, v30
  v_exp_f32 v31, v31
  v_cvt_pk_bf16_f32 v84, v24, v25
  v_cvt_pk_bf16_f32 v85, v26, v27
  v_cvt_pk_bf16_f32 v86, v28, v29
  v_cvt_pk_bf16_f32 v87, v30, v31
  v_exp_f32 v32, v32
  v_exp_f32 v33, v33
  v_mfma_f32_32x32x16_bf16 v[48:63], v[100:103], v[84:87], v[48:63]
  v_exp_f32 v34, v34
  v_exp_f32 v35, v35
  v_exp_f32 v36, v36
  v_exp_f32 v37, v37
  s_waitcnt lgkmcnt(0)
  v_mfma_f32_32x32x16_bf16 v[16:31], v[92:95], v[8:11], 0
  v_exp_f32 v38, v38
  v_exp_f32 v39, v39
  v_cvt_pk_bf16_f32 v80, v32, v33
  v_cvt_pk_bf16_f32 v81, v34, v35
  v_cvt_pk_bf16_f32 v82, v36, v37
  v_cvt_pk_bf16_f32 v83, v38, v39
  v_exp_f32 v40, v40
  v_exp_f32 v41, v41
  v_mfma_f32_32x32x16_bf16 v[64:79], v[96:99], v[80:83], v[64:79]
  v_exp_f32 v42, v42
  v_exp_f32 v43, v43
  s_add_u32 m0, s80, 81920
  s_add_u32 s56, s81, 81920
  v_exp_f32 v44, v44
  buffer_load_dwordx4 v118, s[32:35], s56 offen sc1 lds
  v_exp_f32 v45, v45
  v_exp_f32 v46, v46
  v_exp_f32 v47, v47
  v_cvt_pk_bf16_f32 v84, v40, v41
  v_cvt_pk_bf16_f32 v85, v42, v43
  v_cvt_pk_bf16_f32 v86, v44, v45
  v_cvt_pk_bf16_f32 v87, v46, v47
  v_exp_f32 v16, v16
  v_exp_f32 v17, v17
  v_mfma_f32_32x32x16_bf16 v[64:79], v[100:103], v[84:87], v[64:79]
  v_exp_f32 v18, v18
  v_exp_f32 v19, v19
  ds_read_b64_tr_b16 v[140:141], v114 offset:2560
  ds_read_b64_tr_b16 v[142:143], v114 offset:2816
  v_exp_f32 v20, v20
  ds_read_b128 v[88:91], v112 offset:4096
  s_mov_b64 exec, s[72:73]
  ds_read_b128 v[96:99], v113 offset:4096
  ds_read_b128 v[100:103], v113 offset:4608
  s_mov_b64 exec, -1
  v_exp_f32 v21, v21
  v_mfma_f32_32x32x16_bf16 v[32:47], v[92:95], v[12:15], 0
  v_exp_f32 v22, v22
  v_exp_f32 v23, v23
  v_cvt_pk_bf16_f32 v80, v16, v17
  v_cvt_pk_bf16_f32 v81, v18, v19
  v_cvt_pk_bf16_f32 v82, v20, v21
  v_cvt_pk_bf16_f32 v83, v22, v23
  v_exp_f32 v24, v24
  v_exp_f32 v25, v25
  v_mfma_f32_32x32x16_bf16 v[48:63], v[104:107], v[80:83], v[48:63]
  v_exp_f32 v26, v26
  v_exp_f32 v27, v27
  s_add_u32 m0, s80, 49152
  s_add_u32 s56, s81, 49152
  v_exp_f32 v28, v28
  buffer_load_dwordx4 v118, s[32:35], s56 offen sc1 lds
  v_exp_f32 v29, v29
  v_exp_f32 v30, v30
  v_exp_f32 v31, v31
  v_cvt_pk_bf16_f32 v84, v24, v25
  v_cvt_pk_bf16_f32 v85, v26, v27
  v_cvt_pk_bf16_f32 v86, v28, v29
  v_cvt_pk_bf16_f32 v87, v30, v31
  v_exp_f32 v32, v32
  v_exp_f32 v33, v33
  v_mfma_f32_32x32x16_bf16 v[48:63], v[108:111], v[84:87], v[48:63]
  v_exp_f32 v34, v34
  v_exp_f32 v35, v35
  v_exp_f32 v36, v36
  v_exp_f32 v37, v37
  s_waitcnt lgkmcnt(0)
  v_mfma_f32_32x32x16_bf16 v[16:31], v[88:91], v[8:11], 0
  v_exp_f32 v38, v38
  v_exp_f32 v39, v39
  v_cvt_pk_bf16_f32 v80, v32, v33
  v_cvt_pk_bf16_f32 v81, v34, v35
  v_cvt_pk_bf16_f32 v82, v36, v37
  v_cvt_pk_bf16_f32 v83, v38, v39
  v_exp_f32 v40, v40
  v_exp_f32 v41, v41
  v_mfma_f32_32x32x16_bf16 v[64:79], v[104:107], v[80:83], v[64:79]
  v_exp_f32 v42, v42
  v_exp_f32 v43, v43
  s_add_u32 m0, s80, 114688
  s_add_u32 s56, s81, 114688
  v_exp_f32 v44, v44
  buffer_load_dwordx4 v118, s[32:35], s56 offen sc1 lds
  v_exp_f32 v45, v45
  v_exp_f32 v46, v46
  v_exp_f32 v47, v47
  v_cvt_pk_bf16_f32 v84, v40, v41
  v_cvt_pk_bf16_f32 v85, v42, v43
  v_cvt_pk_bf16_f32 v86, v44, v45
  v_cvt_pk_bf16_f32 v87, v46, v47
  v_exp_f32 v16, v16
  s_add_u32 m0, s70, 2048
  v_exp_f32 v17, v17
  v_mfma_f32_32x32x16_bf16 v[64:79], v[108:111], v[84:87], v[64:79]
  buffer_load_dwordx4 v115, s[36:39], s71 offen lds
  v_exp_f32 v18, v18
  s_add_u32 m0, s70, 3072
  v_exp_f32 v19, v19
  buffer_load_dwordx4 v116, s[40:43], s71 offen lds
  s_add_u32 s71, s71, 114688
  s_waitcnt vmcnt(6)
  ds_read_b64_tr_b16 v[144:145], v114 offset:0
  ds_read_b64_tr_b16 v[146:147], v114 offset:256
  v_exp_f32 v20, v20
  ds_read_b128 v[92:95], v112 offset:5120
  s_mov_b64 exec, s[72:73]
  ds_read_b128 v[104:107], v113 offset:5120
  ds_read_b128 v[108:111], v113 offset:5632
  s_mov_b64 exec, -1
  v_exp_f32 v21, v21
  v_mfma_f32_32x32x16_bf16 v[32:47], v[88:91], v[12:15], 0
  v_exp_f32 v22, v22
  v_exp_f32 v23, v23
  v_cvt_pk_bf16_f32 v80, v16, v17
  v_cvt_pk_bf16_f32 v81, v18, v19
  v_cvt_pk_bf16_f32 v82, v20, v21
  v_cvt_pk_bf16_f32 v83, v22, v23
  v_exp_f32 v24, v24
  v_exp_f32 v25, v25
  v_mfma_f32_32x32x16_bf16 v[48:63], v[96:99], v[80:83], v[48:63]
  v_exp_f32 v26, v26
  v_exp_f32 v27, v27
  s_add_u32 m0, s80, 24576
  s_add_u32 s56, s81, 24576
  v_exp_f32 v28, v28
  buffer_load_dwordx4 v118, s[32:35], s56 offen sc1 lds
  v_exp_f32 v29, v29
  s_add_u32 s57, s82, 0
  s_mov_b64 exec, 0xff
  buffer_load_dword v117, v119, s[32:35], s57 offen
  s_mov_b64 exec, -1
  v_exp_f32 v30, v30
  v_exp_f32 v31, v31
  v_cvt_pk_bf16_f32 v84, v24, v25
  v_cvt_pk_bf16_f32 v85, v26, v27
  v_cvt_pk_bf16_f32 v86, v28, v29
  v_cvt_pk_bf16_f32 v87, v30, v31
  v_exp_f32 v32, v32
  v_exp_f32 v33, v33
  v_mfma_f32_32x32x16_bf16 v[48:63], v[100:103], v[84:87], v[48:63]
  v_exp_f32 v34, v34
  v_exp_f32 v35, v35
  v_exp_f32 v36, v36
  v_exp_f32 v37, v37
  s_waitcnt lgkmcnt(0)
  v_mfma_f32_32x32x16_bf16 v[16:31], v[92:95], v[8:11], 0
  v_exp_f32 v38, v38
  v_exp_f32 v39, v39
  v_cvt_pk_bf16_f32 v80, v32, v33
  v_cvt_pk_bf16_f32 v81, v34, v35
  v_cvt_pk_bf16_f32 v82, v36, v37
  v_cvt_pk_bf16_f32 v83, v38, v39
  v_exp_f32 v40, v40
  v_exp_f32 v41, v41
  v_mfma_f32_32x32x16_bf16 v[64:79], v[96:99], v[80:83], v[64:79]
  v_exp_f32 v42, v42
  v_exp_f32 v43, v43
  s_add_u32 m0, s80, 90112
  s_add_u32 s56, s81, 90112
  v_exp_f32 v44, v44
  buffer_load_dwordx4 v118, s[32:35], s56 offen sc1 lds
  v_exp_f32 v45, v45
  v_exp_f32 v46, v46
  v_exp_f32 v47, v47
  v_cvt_pk_bf16_f32 v84, v40, v41
  v_cvt_pk_bf16_f32 v85, v42, v43
  v_cvt_pk_bf16_f32 v86, v44, v45
  v_cvt_pk_bf16_f32 v87, v46, v47
  v_exp_f32 v16, v16
  v_exp_f32 v17, v17
  v_mfma_f32_32x32x16_bf16 v[64:79], v[100:103], v[84:87], v[64:79]
  v_exp_f32 v18, v18
  v_exp_f32 v19, v19
  ds_read_b64_tr_b16 v[148:149], v114 offset:512
  ds_read_b64_tr_b16 v[150:151], v114 offset:768
  v_exp_f32 v20, v20
  ds_read_b128 v[88:91], v112 offset:6144
  s_mov_b64 exec, s[72:73]
  ds_read_b128 v[96:99], v113 offset:6144
  ds_read_b128 v[100:103], v113 offset:6656
  s_mov_b64 exec, -1
  v_exp_f32 v21, v21
  v_mfma_f32_32x32x16_bf16 v[32:47], v[92:95], v[12:15], 0
  v_exp_f32 v22, v22
  v_exp_f32 v23, v23
  v_cvt_pk_bf16_f32 v80, v16, v17
  v_cvt_pk_bf16_f32 v81, v18, v19
  v_cvt_pk_bf16_f32 v82, v20, v21
  v_cvt_pk_bf16_f32 v83, v22, v23
  v_exp_f32 v24, v24
  v_exp_f32 v25, v25
  v_mfma_f32_32x32x16_bf16 v[48:63], v[104:107], v[80:83], v[48:63]
  v_exp_f32 v26, v26
  v_exp_f32 v27, v27
  s_add_u32 m0, s80, 57344
  s_add_u32 s56, s81, 57344
  v_exp_f32 v28, v28
  buffer_load_dwordx4 v118, s[32:35], s56 offen sc1 lds
  v_exp_f32 v29, v29
  v_exp_f32 v30, v30
  v_exp_f32 v31, v31
  v_cvt_pk_bf16_f32 v84, v24, v25
  v_cvt_pk_bf16_f32 v85, v26, v27
  v_cvt_pk_bf16_f32 v86, v28, v29
  v_cvt_pk_bf16_f32 v87, v30, v31
  v_exp_f32 v32, v32
  v_exp_f32 v33, v33
  v_mfma_f32_32x32x16_bf16 v[48:63], v[108:111], v[84:87], v[48:63]
  v_exp_f32 v34, v34
  v_exp_f32 v35, v35
  v_exp_f32 v36, v36
  v_exp_f32 v37, v37
  s_waitcnt lgkmcnt(0)
  v_mfma_f32_32x32x16_bf16 v[16:31], v[88:91], v[8:11], 0
  v_exp_f32 v38, v38
  v_exp_f32 v39, v39
  v_cvt_pk_bf16_f32 v80, v32, v33
  v_cvt_pk_bf16_f32 v81, v34, v35
  v_cvt_pk_bf16_f32 v82, v36, v37
  v_cvt_pk_bf16_f32 v83, v38, v39
  v_exp_f32 v40, v40
  v_exp_f32 v41, v41
  v_mfma_f32_32x32x16_bf16 v[64:79], v[104:107], v[80:83], v[64:79]
  v_exp_f32 v42, v42
  v_exp_f32 v43, v43
  s_add_u32 m0, s80, 122880
  s_add_u32 s56, s81, 122880
  v_exp_f32 v44, v44
  buffer_load_dwordx4 v118, s[32:35], s56 offen sc1 lds
  v_exp_f32 v45, v45
  v_exp_f32 v46, v46
  v_exp_f32 v47, v47
  v_cvt_pk_bf16_f32 v84, v40, v41
  v_cvt_pk_bf16_f32 v85, v42, v43
  v_cvt_pk_bf16_f32 v86, v44, v45
  v_cvt_pk_bf16_f32 v87, v46, v47
  s_setprio 2
  v_exp_f32 v16, v16
  s_add_u32 m0, s70, 0
  v_exp_f32 v17, v17
  v_mfma_f32_32x32x16_bf16 v[64:79], v[108:111], v[84:87], v[64:79]
  buffer_load_dwordx4 v115, s[36:39], s71 offen lds
  v_exp_f32 v18, v18
  s_add_u32 m0, s70, 1024
  v_exp_f32 v19, v19
  buffer_load_dwordx4 v116, s[40:43], s71 offen lds
  s_add_u32 s71, s71, 114688
  s_waitcnt vmcnt(7)
  ds_read_b64_tr_b16 v[152:153], v114 offset:2048
  ds_read_b64_tr_b16 v[154:155], v114 offset:2304
  v_exp_f32 v20, v20
  ds_read_b128 v[92:95], v112 offset:7168
  s_mov_b64 exec, s[72:73]
  ds_read_b128 v[104:107], v113 offset:7168
  ds_read_b128 v[108:111], v113 offset:7680
  s_mov_b64 exec, -1
  v_exp_f32 v21, v21
  v_mfma_f32_32x32x16_bf16 v[32:47], v[88:91], v[12:15], 0
  v_exp_f32 v22, v22
  v_exp_f32 v23, v23
  v_cvt_pk_bf16_f32 v80, v16, v17
  v_cvt_pk_bf16_f32 v81, v18, v19
  v_cvt_pk_bf16_f32 v82, v20, v21
  v_cvt_pk_bf16_f32 v83, v22, v23
  v_exp_f32 v24, v24
  v_exp_f32 v25, v25
  v_mfma_f32_32x32x16_bf16 v[48:63], v[96:99], v[80:83], v[48:63]
  v_exp_f32 v26, v26
  v_exp_f32 v27, v27
  v_exp_f32 v28, v28
  v_exp_f32 v29, v29
  v_exp_f32 v30, v30
  v_exp_f32 v31, v31
  v_cvt_pk_bf16_f32 v84, v24, v25
  v_cvt_pk_bf16_f32 v85, v26, v27
  v_cvt_pk_bf16_f32 v86, v28, v29
  v_cvt_pk_bf16_f32 v87, v30, v31
  v_exp_f32 v32, v32
  v_exp_f32 v33, v33
  v_mfma_f32_32x32x16_bf16 v[48:63], v[100:103], v[84:87], v[48:63]
  v_exp_f32 v34, v34
  v_exp_f32 v35, v35
  v_exp_f32 v36, v36
  v_exp_f32 v37, v37
  s_waitcnt lgkmcnt(0)
  v_mfma_f32_32x32x16_bf16 v[16:31], v[92:95], v[8:11], 0
  v_exp_f32 v38, v38
  v_exp_f32 v39, v39
  v_cvt_pk_bf16_f32 v80, v32, v33
  v_cvt_pk_bf16_f32 v81, v34, v35
  v_cvt_pk_bf16_f32 v82, v36, v37
  v_cvt_pk_bf16_f32 v83, v38, v39
  v_exp_f32 v40, v40
  v_exp_f32 v41, v41
  v_mfma_f32_32x32x16_bf16 v[64:79], v[96:99], v[80:83], v[64:79]
  v_exp_f32 v42, v42
  v_exp_f32 v43, v43
  v_exp_f32 v44, v44
  v_exp_f32 v45, v45
  v_exp_f32 v46, v46
  v_exp_f32 v47, v47
  v_cvt_pk_bf16_f32 v84, v40, v41
  v_cvt_pk_bf16_f32 v85, v42, v43
  v_cvt_pk_bf16_f32 v86, v44, v45
  v_cvt_pk_bf16_f32 v87, v46, v47
  v_exp_f32 v16, v16
  v_exp_f32 v17, v17
  v_mfma_f32_32x32x16_bf16 v[64:79], v[100:103], v[84:87], v[64:79]
  v_exp_f32 v18, v18
  v_exp_f32 v19, v19
  ds_read_b64_tr_b16 v[156:157], v114 offset:2560
  ds_read_b64_tr_b16 v[158:159], v114 offset:2816
  v_exp_f32 v20, v20
  s_waitcnt vmcnt(2)
  s_barrier
  ds_read_b128 v[88:91], v112 offset:8192
  s_mov_b64 exec, s[72:73]
  ds_read_b128 v[96:99], v113 offset:8192
  ds_read_b128 v[100:103], v113 offset:8704
  s_mov_b64 exec, -1
  v_exp_f32 v21, v21
  v_mfma_f32_32x32x16_bf16 v[32:47], v[92:95], v[12:15], 0
  v_exp_f32 v22, v22
  v_exp_f32 v23, v23
  v_cvt_pk_bf16_f32 v80, v16, v17
  v_cvt_pk_bf16_f32 v81, v18, v19
  v_cvt_pk_bf16_f32 v82, v20, v21
  v_cvt_pk_bf16_f32 v83, v22, v23
  v_exp_f32 v24, v24
  v_exp_f32 v25, v25
  v_mfma_f32_32x32x16_bf16 v[48:63], v[104:107], v[80:83], v[48:63]
  v_exp_f32 v26, v26
  v_exp_f32 v27, v27
  v_exp_f32 v28, v28
  v_exp_f32 v29, v29
  v_exp_f32 v30, v30
  v_exp_f32 v31, v31
  v_cvt_pk_bf16_f32 v84, v24, v25
  v_cvt_pk_bf16_f32 v85, v26, v27
  v_cvt_pk_bf16_f32 v86, v28, v29
  v_cvt_pk_bf16_f32 v87, v30, v31
  v_exp_f32 v32, v32
  v_exp_f32 v33, v33
  v_mfma_f32_32x32x16_bf16 v[48:63], v[108:111], v[84:87], v[48:63]
  v_exp_f32 v34, v34
  v_exp_f32 v35, v35
  v_exp_f32 v36, v36
  v_exp_f32 v37, v37
  s_waitcnt lgkmcnt(0)
  v_mfma_f32_32x32x16_bf16 v[16:31], v[88:91], v[8:11], 0
  v_exp_f32 v38, v38
  v_exp_f32 v39, v39
  v_cvt_pk_bf16_f32 v80, v32, v33
  v_cvt_pk_bf16_f32 v81, v34, v35
  v_cvt_pk_bf16_f32 v82, v36, v37
  v_cvt_pk_bf16_f32 v83, v38, v39
  v_exp_f32 v40, v40
  v_exp_f32 v41, v41
  v_mfma_f32_32x32x16_bf16 v[64:79], v[104:107], v[80:83], v[64:79]
  v_exp_f32 v42, v42
  v_exp_f32 v43, v43
  v_exp_f32 v44, v44
  v_exp_f32 v45, v45
  v_exp_f32 v46, v46
  v_exp_f32 v47, v47
  v_cvt_pk_bf16_f32 v84, v40, v41
  v_cvt_pk_bf16_f32 v85, v42, v43
  v_cvt_pk_bf16_f32 v86, v44, v45
  v_cvt_pk_bf16_f32 v87, v46, v47
  v_exp_f32 v16, v16
  s_add_u32 m0, s70, 2048
  v_exp_f32 v17, v17
  v_mfma_f32_32x32x16_bf16 v[64:79], v[108:111], v[84:87], v[64:79]
  buffer_load_dwordx4 v115, s[36:39], s71 offen lds
  v_exp_f32 v18, v18
  s_add_u32 m0, s70, 3072
  v_exp_f32 v19, v19
  buffer_load_dwordx4 v116, s[40:43], s71 offen lds
  s_add_u32 s71, s71, 114688
  s_waitcnt vmcnt(2)
  ds_read_b64_tr_b16 v[160:161], v114 offset:0
  ds_read_b64_tr_b16 v[162:163], v114 offset:256
  v_exp_f32 v20, v20
  ds_read_b128 v[92:95], v112 offset:9216
  s_mov_b64 exec, s[72:73]
  ds_read_b128 v[104:107], v113 offset:9216
  ds_read_b128 v[108:111], v113 offset:9728
  s_mov_b64 exec, -1
  v_exp_f32 v21, v21
  v_mfma_f32_32x32x16_bf16 v[32:47], v[88:91], v[12:15], 0
  v_exp_f32 v22, v22
  v_exp_f32 v23, v23
  v_cvt_pk_bf16_f32 v80, v16, v17
  v_cvt_pk_bf16_f32 v81, v18, v19
  v_cvt_pk_bf16_f32 v82, v20, v21
  v_cvt_pk_bf16_f32 v83, v22, v23
  v_exp_f32 v24, v24
  v_exp_f32 v25, v25
  v_mfma_f32_32x32x16_bf16 v[48:63], v[96:99], v[80:83], v[48:63]
  v_exp_f32 v26, v26
  v_exp_f32 v27, v27
  v_exp_f32 v28, v28
  v_exp_f32 v29, v29
  s_add_u32 s57, s83, 0
  s_mov_b64 exec, 0xff
  buffer_load_dword v117, v119, s[32:35], s57 offen
  s_mov_b64 exec, -1
  v_exp_f32 v30, v30
  v_exp_f32 v31, v31
  v_cvt_pk_bf16_f32 v84, v24, v25
  v_cvt_pk_bf16_f32 v85, v26, v27
  v_cvt_pk_bf16_f32 v86, v28, v29
  v_cvt_pk_bf16_f32 v87, v30, v31
  v_exp_f32 v32, v32
  v_exp_f32 v33, v33
  v_mfma_f32_32x32x16_bf16 v[48:63], v[100:103], v[84:87], v[48:63]
  v_exp_f32 v34, v34
  v_exp_f32 v35, v35
  v_exp_f32 v36, v36
  v_exp_f32 v37, v37
  s_waitcnt lgkmcnt(0)
  v_mfma_f32_32x32x16_bf16 v[16:31], v[92:95], v[8:11], 0
  v_exp_f32 v38, v38
  v_exp_f32 v39, v39
  v_cvt_pk_bf16_f32 v80, v32, v33
  v_cvt_pk_bf16_f32 v81, v34, v35
  v_cvt_pk_bf16_f32 v82, v36, v37
  v_cvt_pk_bf16_f32 v83, v38, v39
  v_exp_f32 v40, v40
  v_exp_f32 v41, v41
  v_mfma_f32_32x32x16_bf16 v[64:79], v[96:99], v[80:83], v[64:79]
  v_exp_f32 v42, v42
  v_exp_f32 v43, v43
  v_exp_f32 v44, v44
  v_exp_f32 v45, v45
  v_exp_f32 v46, v46
  v_exp_f32 v47, v47
  v_cvt_pk_bf16_f32 v84, v40, v41
  v_cvt_pk_bf16_f32 v85, v42, v43
  v_cvt_pk_bf16_f32 v86, v44, v45
  v_cvt_pk_bf16_f32 v87, v46, v47
  v_exp_f32 v16, v16
  v_exp_f32 v17, v17
  v_mfma_f32_32x32x16_bf16 v[64:79], v[100:103], v[84:87], v[64:79]
  v_exp_f32 v18, v18
  v_exp_f32 v19, v19
  ds_read_b64_tr_b16 v[164:165], v114 offset:512
  ds_read_b64_tr_b16 v[166:167], v114 offset:768
  v_exp_f32 v20, v20
  ds_read_b128 v[88:91], v112 offset:10240
  s_mov_b64 exec, s[72:73]
  ds_read_b128 v[96:99], v113 offset:10240
  ds_read_b128 v[100:103], v113 offset:10752
  s_mov_b64 exec, -1
  v_exp_f32 v21, v21
  v_mfma_f32_32x32x16_bf16 v[32:47], v[92:95], v[12:15], 0
  v_exp_f32 v22, v22
  v_exp_f32 v23, v23
  v_cvt_pk_bf16_f32 v80, v16, v17
  v_cvt_pk_bf16_f32 v81, v18, v19
  v_cvt_pk_bf16_f32 v82, v20, v21
  v_cvt_pk_bf16_f32 v83, v22, v23
  v_exp_f32 v24, v24
  v_exp_f32 v25, v25
  v_mfma_f32_32x32x16_bf16 v[48:63], v[104:107], v[80:83], v[48:63]
  v_exp_f32 v26, v26
  v_exp_f32 v27, v27
  v_exp_f32 v28, v28
  v_exp_f32 v29, v29
  v_exp_f32 v30, v30
  v_exp_f32 v31, v31
  v_cvt_pk_bf16_f32 v84, v24, v25
  v_cvt_pk_bf16_f32 v85, v26, v27
  v_cvt_pk_bf16_f32 v86, v28, v29
  v_cvt_pk_bf16_f32 v87, v30, v31
  v_exp_f32 v32, v32
  v_exp_f32 v33, v33
  v_mfma_f32_32x32x16_bf16 v[48:63], v[108:111], v[84:87], v[48:63]
  v_exp_f32 v34, v34
  v_exp_f32 v35, v35
  v_exp_f32 v36, v36
  v_exp_f32 v37, v37
  s_waitcnt lgkmcnt(0)
  v_mfma_f32_32x32x16_bf16 v[16:31], v[88:91], v[8:11], 0
  v_exp_f32 v38, v38
  v_exp_f32 v39, v39
  v_cvt_pk_bf16_f32 v80, v32, v33
  v_cvt_pk_bf16_f32 v81, v34, v35
  v_cvt_pk_bf16_f32 v82, v36, v37
  v_cvt_pk_bf16_f32 v83, v38, v39
  v_exp_f32 v40, v40
  v_exp_f32 v41, v41
  v_mfma_f32_32x32x16_bf16 v[64:79], v[104:107], v[80:83], v[64:79]
  v_exp_f32 v42, v42
  v_exp_f32 v43, v43
  v_exp_f32 v44, v44
  v_exp_f32 v45, v45
  v_exp_f32 v46, v46
  v_exp_f32 v47, v47
  v_cvt_pk_bf16_f32 v84, v40, v41
  v_cvt_pk_bf16_f32 v85, v42, v43
  v_cvt_pk_bf16_f32 v86, v44, v45
  v_cvt_pk_bf16_f32 v87, v46, v47
  v_exp_f32 v16, v16
  s_add_u32 m0, s70, 0
  v_exp_f32 v17, v17
  v_mfma_f32_32x32x16_bf16 v[64:79], v[108:111], v[84:87], v[64:79]
  buffer_load_dwordx4 v115, s[36:39], s71 offen lds
  v_exp_f32 v18, v18
  s_add_u32 m0, s70, 1024
  v_exp_f32 v19, v19
  buffer_load_dwordx4 v116, s[40:43], s71 offen lds
  s_add_u32 s71, s71, 114688
  s_waitcnt vmcnt(3)
  ds_read_b64_tr_b16 v[168:169], v114 offset:2048
  ds_read_b64_tr_b16 v[170:171], v114 offset:2304
  v_exp_f32 v20, v20
  ds_read_b128 v[92:95], v112 offset:11264
  s_mov_b64 exec, s[72:73]
  ds_read_b128 v[104:107], v113 offset:11264
  ds_read_b128 v[108:111], v113 offset:11776
  s_mov_b64 exec, -1
  v_exp_f32 v21, v21
  v_mfma_f32_32x32x16_bf16 v[32:47], v[88:91], v[12:15], 0
  v_exp_f32 v22, v22
  v_exp_f32 v23, v23
  v_cvt_pk_bf16_f32 v80, v16, v17
  v_cvt_pk_bf16_f32 v81, v18, v19
  v_cvt_pk_bf16_f32 v82, v20, v21
  v_cvt_pk_bf16_f32 v83, v22, v23
  v_exp_f32 v24, v24
  v_exp_f32 v25, v25
  v_mfma_f32_32x32x16_bf16 v[48:63], v[96:99], v[80:83], v[48:63]
  v_exp_f32 v26, v26
  v_exp_f32 v27, v27
  v_exp_f32 v28, v28
  v_exp_f32 v29, v29
  v_exp_f32 v30, v30
  v_exp_f32 v31, v31
  v_cvt_pk_bf16_f32 v84, v24, v25
  v_cvt_pk_bf16_f32 v85, v26, v27
  v_cvt_pk_bf16_f32 v86, v28, v29
  v_cvt_pk_bf16_f32 v87, v30, v31
  v_exp_f32 v32, v32
  v_exp_f32 v33, v33
  v_mfma_f32_32x32x16_bf16 v[48:63], v[100:103], v[84:87], v[48:63]
  v_exp_f32 v34, v34
  v_exp_f32 v35, v35
  v_exp_f32 v36, v36
  v_exp_f32 v37, v37
  s_waitcnt lgkmcnt(0)
  v_mfma_f32_32x32x16_bf16 v[16:31], v[92:95], v[8:11], 0
  v_exp_f32 v38, v38
  v_exp_f32 v39, v39
  v_cvt_pk_bf16_f32 v80, v32, v33
  v_cvt_pk_bf16_f32 v81, v34, v35
  v_cvt_pk_bf16_f32 v82, v36, v37
  v_cvt_pk_bf16_f32 v83, v38, v39
  v_exp_f32 v40, v40
  v_exp_f32 v41, v41
  v_mfma_f32_32x32x16_bf16 v[64:79], v[96:99], v[80:83], v[64:79]
  v_exp_f32 v42, v42
  v_exp_f32 v43, v43
  v_exp_f32 v44, v44
  v_exp_f32 v45, v45
  s_lshl_b32 s54, s2, 3
  s_add_u32 s54, s54, s52
  s_lshl_b32 s54, s54, 3
  v_add_u32 v2, s54, v1
  v_lshrrev_b32 v3, 5, v2
  v_mul_u32_u24 v3, 6144, v3
  v_and_b32 v2, 31, v2
  v_lshl_add_u32 v2, v2, 7, v3
  s_mov_b32 s44, s24
  s_mov_b32 s45, s25
  s_mov_b32 s46, 3145728
  s_mov_b32 s47, 0x20000
  s_mov_b64 exec, 0xff
  buffer_load_dword v117, v2, s[44:47], 0 offen offset:2048
  s_mov_b64 exec, -1
  v_exp_f32 v46, v46
  v_exp_f32 v47, v47
  v_cvt_pk_bf16_f32 v84, v40, v41
  v_cvt_pk_bf16_f32 v85, v42, v43
  v_cvt_pk_bf16_f32 v86, v44, v45
  v_cvt_pk_bf16_f32 v87, v46, v47
  v_exp_f32 v16, v16
  v_exp_f32 v17, v17
  v_mfma_f32_32x32x16_bf16 v[64:79], v[100:103], v[84:87], v[64:79]
  v_exp_f32 v18, v18
  v_exp_f32 v19, v19
  ds_read_b64_tr_b16 v[172:173], v114 offset:2560
  ds_read_b64_tr_b16 v[174:175], v114 offset:2816
  v_exp_f32 v20, v20
  ds_read_b128 v[88:91], v112 offset:12288
  s_mov_b64 exec, s[72:73]
  ds_read_b128 v[96:99], v113 offset:12288
  ds_read_b128 v[100:103], v113 offset:12800
  s_mov_b64 exec, -1
  v_exp_f32 v21, v21
  v_mfma_f32_32x32x16_bf16 v[32:47], v[92:95], v[12:15], 0
  v_exp_f32 v22, v22
  v_exp_f32 v23, v23
  v_cvt_pk_bf16_f32 v80, v16, v17
  v_cvt_pk_bf16_f32 v81, v18, v19
  v_cvt_pk_bf16_f32 v82, v20, v21
  v_cvt_pk_bf16_f32 v83, v22, v23
  v_exp_f32 v24, v24
  v_exp_f32 v25, v25
  v_mfma_f32_32x32x16_bf16 v[48:63], v[104:107], v[80:83], v[48:63]
  v_exp_f32 v26, v26
  v_exp_f32 v27, v27
  v_exp_f32 v28, v28
  v_exp_f32 v29, v29
  v_exp_f32 v30, v30
  v_exp_f32 v31, v31
  v_cvt_pk_bf16_f32 v84, v24, v25
  v_cvt_pk_bf16_f32 v85, v26, v27
  v_cvt_pk_bf16_f32 v86, v28, v29
  v_cvt_pk_bf16_f32 v87, v30, v31
  v_exp_f32 v32, v32
  v_exp_f32 v33, v33
  v_mfma_f32_32x32x16_bf16 v[48:63], v[108:111], v[84:87], v[48:63]
  v_exp_f32 v34, v34
  v_exp_f32 v35, v35
  v_exp_f32 v36, v36
  v_exp_f32 v37, v37
  s_waitcnt lgkmcnt(0)
  v_mfma_f32_32x32x16_bf16 v[16:31], v[88:91], v[8:11], 0
  v_exp_f32 v38, v38
  v_exp_f32 v39, v39
  v_cvt_pk_bf16_f32 v80, v32, v33
  v_cvt_pk_bf16_f32 v81, v34, v35
  v_cvt_pk_bf16_f32 v82, v36, v37
  v_cvt_pk_bf16_f32 v83, v38, v39
  v_exp_f32 v40, v40
  v_exp_f32 v41, v41
  v_mfma_f32_32x32x16_bf16 v[64:79], v[104:107], v[80:83], v[64:79]
  v_exp_f32 v42, v42
  v_exp_f32 v43, v43
  v_exp_f32 v44, v44
  v_exp_f32 v45, v45
  v_exp_f32 v46, v46
  v_exp_f32 v47, v47
  v_cvt_pk_bf16_f32 v84, v40, v41
  v_cvt_pk_bf16_f32 v85, v42, v43
  v_cvt_pk_bf16_f32 v86, v44, v45
  v_cvt_pk_bf16_f32 v87, v46, v47
  v_exp_f32 v16, v16
  s_add_u32 m0, s70, 2048
  v_exp_f32 v17, v17
  v_mfma_f32_32x32x16_bf16 v[64:79], v[108:111], v[84:87], v[64:79]
  buffer_load_dwordx4 v115, s[36:39], s71 offen lds
  v_exp_f32 v18, v18
  s_add_u32 m0, s70, 3072
  v_exp_f32 v19, v19
  buffer_load_dwordx4 v116, s[40:43], s71 offen lds
  s_add_u32 s71, s71, 114688
  s_waitcnt vmcnt(3)
  ds_read_b64_tr_b16 v[176:177], v114 offset:0
  ds_read_b64_tr_b16 v[178:179], v114 offset:256
  v_exp_f32 v20, v20
  ds_read_b128 v[92:95], v112 offset:13312
  s_mov_b64 exec, s[72:73]
  ds_read_b128 v[104:107], v113 offset:13312
  ds_read_b128 v[108:111], v113 offset:13824
  s_mov_b64 exec, -1
  v_exp_f32 v21, v21
  v_mfma_f32_32x32x16_bf16 v[32:47], v[88:91], v[12:15], 0
  v_exp_f32 v22, v22
  v_exp_f32 v23, v23
  v_cvt_pk_bf16_f32 v80, v16, v17
  v_cvt_pk_bf16_f32 v81, v18, v19
  v_cvt_pk_bf16_f32 v82, v20, v21
  v_cvt_pk_bf16_f32 v83, v22, v23
  v_exp_f32 v24, v24
  v_exp_f32 v25, v25
  v_mfma_f32_32x32x16_bf16 v[48:63], v[96:99], v[80:83], v[48:63]
  v_exp_f32 v26, v26
  v_exp_f32 v27, v27
  v_exp_f32 v28, v28
  v_exp_f32 v29, v29
  s_add_u32 s57, s84, 0
  s_mov_b64 exec, 0xff
  buffer_load_dword v117, v119, s[32:35], s57 offen
  s_mov_b64 exec, -1
  v_exp_f32 v30, v30
  v_exp_f32 v31, v31
  v_cvt_pk_bf16_f32 v84, v24, v25
  v_cvt_pk_bf16_f32 v85, v26, v27
  v_cvt_pk_bf16_f32 v86, v28, v29
  v_cvt_pk_bf16_f32 v87, v30, v31
  v_exp_f32 v32, v32
  v_exp_f32 v33, v33
  v_mfma_f32_32x32x16_bf16 v[48:63], v[100:103], v[84:87], v[48:63]
  v_exp_f32 v34, v34
  v_exp_f32 v35, v35
  v_exp_f32 v36, v36
  v_exp_f32 v37, v37
  s_waitcnt lgkmcnt(0)
  v_mfma_f32_32x32x16_bf16 v[16:31], v[92:95], v[8:11], 0
  v_exp_f32 v38, v38
  v_exp_f32 v39, v39
  v_cvt_pk_bf16_f32 v80, v32, v33
  v_cvt_pk_bf16_f32 v81, v34, v35
  v_cvt_pk_bf16_f32 v82, v36, v37
  v_cvt_pk_bf16_f32 v83, v38, v39
  v_exp_f32 v40, v40
  v_exp_f32 v41, v41
  v_mfma_f32_32x32x16_bf16 v[64:79], v[96:99], v[80:83], v[64:79]
  v_exp_f32 v42, v42
  v_exp_f32 v43, v43
  v_exp_f32 v44, v44
  v_exp_f32 v45, v45
  v_exp_f32 v46, v46
  v_exp_f32 v47, v47
  v_cvt_pk_bf16_f32 v84, v40, v41
  v_cvt_pk_bf16_f32 v85, v42, v43
  v_cvt_pk_bf16_f32 v86, v44, v45
  v_cvt_pk_bf16_f32 v87, v46, v47
  v_exp_f32 v16, v16
  v_exp_f32 v17, v17
  v_mfma_f32_32x32x16_bf16 v[64:79], v[100:103], v[84:87], v[64:79]
  v_exp_f32 v18, v18
  v_exp_f32 v19, v19
  ds_read_b64_tr_b16 v[180:181], v114 offset:512
  ds_read_b64_tr_b16 v[182:183], v114 offset:768
  v_exp_f32 v20, v20
  ds_read_b128 v[88:91], v112 offset:14336
  s_mov_b64 exec, s[72:73]
  ds_read_b128 v[96:99], v113 offset:14336
  ds_read_b128 v[100:103], v113 offset:14848
  s_mov_b64 exec, -1
  v_exp_f32 v21, v21
  v_mfma_f32_32x32x16_bf16 v[32:47], v[92:95], v[12:15], 0
  v_exp_f32 v22, v22
  v_exp_f32 v23, v23
  v_cvt_pk_bf16_f32 v80, v16, v17
  v_cvt_pk_bf16_f32 v81, v18, v19
  v_cvt_pk_bf16_f32 v82, v20, v21
  v_cvt_pk_bf16_f32 v83, v22, v23
  v_exp_f32 v24, v24
  v_exp_f32 v25, v25
  v_mfma_f32_32x32x16_bf16 v[48:63], v[104:107], v[80:83], v[48:63]
  v_exp_f32 v26, v26
  v_exp_f32 v27, v27
  v_exp_f32 v28, v28
  v_exp_f32 v29, v29
  v_exp_f32 v30, v30
  v_exp_f32 v31, v31
  v_cvt_pk_bf16_f32 v84, v24, v25
  v_cvt_pk_bf16_f32 v85, v26, v27
  v_cvt_pk_bf16_f32 v86, v28, v29
  v_cvt_pk_bf16_f32 v87, v30, v31
  v_exp_f32 v32, v32
  v_exp_f32 v33, v33
  v_mfma_f32_32x32x16_bf16 v[48:63], v[108:111], v[84:87], v[48:63]
  v_exp_f32 v34, v34
  v_exp_f32 v35, v35
  v_exp_f32 v36, v36
  v_exp_f32 v37, v37
  s_waitcnt lgkmcnt(0)
  v_mfma_f32_32x32x16_bf16 v[16:31], v[88:91], v[8:11], 0
  v_exp_f32 v38, v38
  v_exp_f32 v39, v39
  v_cvt_pk_bf16_f32 v80, v32, v33
  v_cvt_pk_bf16_f32 v81, v34, v35
  v_cvt_pk_bf16_f32 v82, v36, v37
  v_cvt_pk_bf16_f32 v83, v38, v39
  v_exp_f32 v40, v40
  v_exp_f32 v41, v41
  v_mfma_f32_32x32x16_bf16 v[64:79], v[104:107], v[80:83], v[64:79]
  v_exp_f32 v42, v42
  v_exp_f32 v43, v43
  v_exp_f32 v44, v44
  v_exp_f32 v45, v45
  v_exp_f32 v46, v46
  v_exp_f32 v47, v47
  v_cvt_pk_bf16_f32 v84, v40, v41
  v_cvt_pk_bf16_f32 v85, v42, v43
  v_cvt_pk_bf16_f32 v86, v44, v45
  v_cvt_pk_bf16_f32 v87, v46, v47
  v_exp_f32 v16, v16
  s_add_u32 m0, s70, 0
  v_exp_f32 v17, v17
  v_mfma_f32_32x32x16_bf16 v[64:79], v[108:111], v[84:87], v[64:79]
  buffer_load_dwordx4 v115, s[36:39], s71 offen lds
  v_exp_f32 v18, v18
  s_add_u32 m0, s70, 1024
  v_exp_f32 v19, v19
  buffer_load_dwordx4 v116, s[40:43], s71 offen lds
  s_add_u32 s71, s71, 114688
  s_waitcnt vmcnt(3)
  ds_read_b64_tr_b16 v[184:185], v114 offset:2048
  ds_read_b64_tr_b16 v[186:187], v114 offset:2304
  v_exp_f32 v20, v20
  ds_read_b128 v[92:95], v112 offset:15360
  s_mov_b64 exec, s[72:73]
  ds_read_b128 v[104:107], v113 offset:15360
  ds_read_b128 v[108:111], v113 offset:15872
  s_mov_b64 exec, -1
  v_exp_f32 v21, v21
  v_mfma_f32_32x32x16_bf16 v[32:47], v[88:91], v[12:15], 0
  v_exp_f32 v22, v22
  v_exp_f32 v23, v23
  v_cvt_pk_bf16_f32 v80, v16, v17
  v_cvt_pk_bf16_f32 v81, v18, v19
  v_cvt_pk_bf16_f32 v82, v20, v21
  v_cvt_pk_bf16_f32 v83, v22, v23
  v_exp_f32 v24, v24
  v_exp_f32 v25, v25
  v_mfma_f32_32x32x16_bf16 v[48:63], v[96:99], v[80:83], v[48:63]
  v_exp_f32 v26, v26
  v_exp_f32 v27, v27
  v_exp_f32 v28, v28
  v_exp_f32 v29, v29
  v_exp_f32 v30, v30
  v_exp_f32 v31, v31
  v_cvt_pk_bf16_f32 v84, v24, v25
  v_cvt_pk_bf16_f32 v85, v26, v27
  v_cvt_pk_bf16_f32 v86, v28, v29
  v_cvt_pk_bf16_f32 v87, v30, v31
  v_exp_f32 v32, v32
  v_exp_f32 v33, v33
  v_mfma_f32_32x32x16_bf16 v[48:63], v[100:103], v[84:87], v[48:63]
  v_exp_f32 v34, v34
  v_exp_f32 v35, v35
  v_exp_f32 v36, v36
  v_exp_f32 v37, v37
  s_waitcnt lgkmcnt(0)
  v_mfma_f32_32x32x16_bf16 v[16:31], v[92:95], v[8:11], 0
  v_exp_f32 v38, v38
  v_exp_f32 v39, v39
  v_cvt_pk_bf16_f32 v80, v32, v33
  v_cvt_pk_bf16_f32 v81, v34, v35
  v_cvt_pk_bf16_f32 v82, v36, v37
  v_cvt_pk_bf16_f32 v83, v38, v39
  v_exp_f32 v40, v40
  v_exp_f32 v41, v41
  v_mfma_f32_32x32x16_bf16 v[64:79], v[96:99], v[80:83], v[64:79]
  v_exp_f32 v42, v42
  v_exp_f32 v43, v43
  v_exp_f32 v44, v44
  v_exp_f32 v45, v45
  v_exp_f32 v46, v46
  v_exp_f32 v47, v47
  v_cvt_pk_bf16_f32 v84, v40, v41
  v_cvt_pk_bf16_f32 v85, v42, v43
  v_cvt_pk_bf16_f32 v86, v44, v45
  v_cvt_pk_bf16_f32 v87, v46, v47
  v_exp_f32 v16, v16
  v_exp_f32 v17, v17
  v_mfma_f32_32x32x16_bf16 v[64:79], v[100:103], v[84:87], v[64:79]
  v_exp_f32 v18, v18
  v_exp_f32 v19, v19
  ds_read_b64_tr_b16 v[188:189], v114 offset:2560
  ds_read_b64_tr_b16 v[190:191], v114 offset:2816
  v_exp_f32 v20, v20
  ds_read_b128 v[88:91], v112 offset:16384
  s_mov_b64 exec, s[72:73]
  ds_read_b128 v[96:99], v113 offset:16384
  ds_read_b128 v[100:103], v113 offset:16896
  s_mov_b64 exec, -1
  v_exp_f32 v21, v21
  v_mfma_f32_32x32x16_bf16 v[32:47], v[92:95], v[12:15], 0
  v_exp_f32 v22, v22
  v_exp_f32 v23, v23
  v_cvt_pk_bf16_f32 v80, v16, v17
  v_cvt_pk_bf16_f32 v81, v18, v19
  v_cvt_pk_bf16_f32 v82, v20, v21
  v_cvt_pk_bf16_f32 v83, v22, v23
  v_exp_f32 v24, v24
  v_exp_f32 v25, v25
  v_mfma_f32_32x32x16_bf16 v[48:63], v[104:107], v[80:83], v[48:63]
  v_exp_f32 v26, v26
  v_exp_f32 v27, v27
  v_exp_f32 v28, v28
  v_exp_f32 v29, v29
  v_exp_f32 v30, v30
  v_exp_f32 v31, v31
  v_cvt_pk_bf16_f32 v84, v24, v25
  v_cvt_pk_bf16_f32 v85, v26, v27
  v_cvt_pk_bf16_f32 v86, v28, v29
  v_cvt_pk_bf16_f32 v87, v30, v31
  v_exp_f32 v32, v32
  v_exp_f32 v33, v33
  v_mfma_f32_32x32x16_bf16 v[48:63], v[108:111], v[84:87], v[48:63]
  v_exp_f32 v34, v34
  v_exp_f32 v35, v35
  v_exp_f32 v36, v36
  v_exp_f32 v37, v37
  s_waitcnt lgkmcnt(0)
  v_mfma_f32_32x32x16_bf16 v[16:31], v[88:91], v[8:11], 0
  v_exp_f32 v38, v38
  v_exp_f32 v39, v39
  v_cvt_pk_bf16_f32 v80, v32, v33
  v_cvt_pk_bf16_f32 v81, v34, v35
  v_cvt_pk_bf16_f32 v82, v36, v37
  v_cvt_pk_bf16_f32 v83, v38, v39
  v_exp_f32 v40, v40
  v_exp_f32 v41, v41
  v_mfma_f32_32x32x16_bf16 v[64:79], v[104:107], v[80:83], v[64:79]
  v_exp_f32 v42, v42
  v_exp_f32 v43, v43
  v_exp_f32 v44, v44
  v_exp_f32 v45, v45
  v_exp_f32 v46, v46
  v_exp_f32 v47, v47
  v_cvt_pk_bf16_f32 v84, v40, v41
  v_cvt_pk_bf16_f32 v85, v42, v43
  v_cvt_pk_bf16_f32 v86, v44, v45
  v_cvt_pk_bf16_f32 v87, v46, v47
  v_exp_f32 v16, v16
  s_add_u32 m0, s70, 2048
  v_exp_f32 v17, v17
  v_mfma_f32_32x32x16_bf16 v[64:79], v[108:111], v[84:87], v[64:79]
  buffer_load_dwordx4 v115, s[36:39], s71 offen lds
  v_exp_f32 v18, v18
  s_add_u32 m0, s70, 3072
  v_exp_f32 v19, v19
  buffer_load_dwordx4 v116, s[40:43], s71 offen lds
  s_add_u32 s71, s71, 114688
  s_waitcnt vmcnt(2)
  ds_read_b64_tr_b16 v[192:193], v114 offset:0
  ds_read_b64_tr_b16 v[194:195], v114 offset:256
  v_exp_f32 v20, v20
  ds_read_b128 v[92:95], v112 offset:17408
  s_mov_b64 exec, s[72:73]
  ds_read_b128 v[104:107], v113 offset:17408
  ds_read_b128 v[108:111], v113 offset:17920
  s_mov_b64 exec, -1
  v_exp_f32 v21, v21
  v_mfma_f32_32x32x16_bf16 v[32:47], v[88:91], v[12:15], 0
  v_exp_f32 v22, v22
  v_exp_f32 v23, v23
  v_cvt_pk_bf16_f32 v80, v16, v17
  v_cvt_pk_bf16_f32 v81, v18, v19
  v_cvt_pk_bf16_f32 v82, v20, v21
  v_cvt_pk_bf16_f32 v83, v22, v23
  v_exp_f32 v24, v24
  v_exp_f32 v25, v25
  v_mfma_f32_32x32x16_bf16 v[48:63], v[96:99], v[80:83], v[48:63]
  v_exp_f32 v26, v26
  v_exp_f32 v27, v27
  v_exp_f32 v28, v28
  v_exp_f32 v29, v29
  s_add_u32 s57, s84, 114688
  s_mov_b64 exec, 0xff
  buffer_load_dword v117, v119, s[32:35], s57 offen
  s_mov_b64 exec, -1
  v_exp_f32 v30, v30
  v_exp_f32 v31, v31
  v_cvt_pk_bf16_f32 v84, v24, v25
  v_cvt_pk_bf16_f32 v85, v26, v27
  v_cvt_pk_bf16_f32 v86, v28, v29
  v_cvt_pk_bf16_f32 v87, v30, v31
  v_exp_f32 v32, v32
  v_exp_f32 v33, v33
  v_mfma_f32_32x32x16_bf16 v[48:63], v[100:103], v[84:87], v[48:63]
  v_exp_f32 v34, v34
  v_exp_f32 v35, v35
  v_exp_f32 v36, v36
  v_exp_f32 v37, v37
  s_waitcnt lgkmcnt(0)
  v_mfma_f32_32x32x16_bf16 v[16:31], v[92:95], v[8:11], 0
  v_exp_f32 v38, v38
  v_exp_f32 v39, v39
  v_cvt_pk_bf16_f32 v80, v32, v33
  v_cvt_pk_bf16_f32 v81, v34, v35
  v_cvt_pk_bf16_f32 v82, v36, v37
  v_cvt_pk_bf16_f32 v83, v38, v39
  v_exp_f32 v40, v40
  v_exp_f32 v41, v41
  v_mfma_f32_32x32x16_bf16 v[64:79], v[96:99], v[80:83], v[64:79]
  v_exp_f32 v42, v42
  v_exp_f32 v43, v43
  v_exp_f32 v44, v44
  v_exp_f32 v45, v45
  v_exp_f32 v46, v46
  v_exp_f32 v47, v47
  v_cvt_pk_bf16_f32 v84, v40, v41
  v_cvt_pk_bf16_f32 v85, v42, v43
  v_cvt_pk_bf16_f32 v86, v44, v45
  v_cvt_pk_bf16_f32 v87, v46, v47
  v_exp_f32 v16, v16
  v_exp_f32 v17, v17
  v_mfma_f32_32x32x16_bf16 v[64:79], v[100:103], v[84:87], v[64:79]
  v_exp_f32 v18, v18
  v_exp_f32 v19, v19
  ds_read_b64_tr_b16 v[196:197], v114 offset:512
  ds_read_b64_tr_b16 v[198:199], v114 offset:768
  v_exp_f32 v20, v20
  ds_read_b128 v[88:91], v112 offset:18432
  s_mov_b64 exec, s[72:73]
  ds_read_b128 v[96:99], v113 offset:18432
  ds_read_b128 v[100:103], v113 offset:18944
  s_mov_b64 exec, -1
  v_exp_f32 v21, v21
  v_mfma_f32_32x32x16_bf16 v[32:47], v[92:95], v[12:15], 0
  v_exp_f32 v22, v22
  v_exp_f32 v23, v23
  v_cvt_pk_bf16_f32 v80, v16, v17
  v_cvt_pk_bf16_f32 v81, v18, v19
  v_cvt_pk_bf16_f32 v82, v20, v21
  v_cvt_pk_bf16_f32 v83, v22, v23
  v_exp_f32 v24, v24
  v_exp_f32 v25, v25
  v_mfma_f32_32x32x16_bf16 v[48:63], v[104:107], v[80:83], v[48:63]
  v_exp_f32 v26, v26
  v_exp_f32 v27, v27
  v_exp_f32 v28, v28
  v_exp_f32 v29, v29
  v_exp_f32 v30, v30
  v_exp_f32 v31, v31
  v_cvt_pk_bf16_f32 v84, v24, v25
  v_cvt_pk_bf16_f32 v85, v26, v27
  v_cvt_pk_bf16_f32 v86, v28, v29
  v_cvt_pk_bf16_f32 v87, v30, v31
  v_exp_f32 v32, v32
  v_exp_f32 v33, v33
  v_mfma_f32_32x32x16_bf16 v[48:63], v[108:111], v[84:87], v[48:63]
  v_exp_f32 v34, v34
  v_exp_f32 v35, v35
  v_exp_f32 v36, v36
  v_exp_f32 v37, v37
  s_waitcnt lgkmcnt(0)
  v_mfma_f32_32x32x16_bf16 v[16:31], v[88:91], v[8:11], 0
  v_exp_f32 v38, v38
  v_exp_f32 v39, v39
  v_cvt_pk_bf16_f32 v80, v32, v33
  v_cvt_pk_bf16_f32 v81, v34, v35
  v_cvt_pk_bf16_f32 v82, v36, v37
  v_cvt_pk_bf16_f32 v83, v38, v39
  v_exp_f32 v40, v40
  v_exp_f32 v41, v41
  v_mfma_f32_32x32x16_bf16 v[64:79], v[104:107], v[80:83], v[64:79]
  v_exp_f32 v42, v42
  v_exp_f32 v43, v43
  v_exp_f32 v44, v44
  v_exp_f32 v45, v45
  v_exp_f32 v46, v46
  v_exp_f32 v47, v47
  v_cvt_pk_bf16_f32 v84, v40, v41
  v_cvt_pk_bf16_f32 v85, v42, v43
  v_cvt_pk_bf16_f32 v86, v44, v45
  v_cvt_pk_bf16_f32 v87, v46, v47
  v_exp_f32 v16, v16
  s_add_u32 m0, s70, 0
  v_exp_f32 v17, v17
  v_mfma_f32_32x32x16_bf16 v[64:79], v[108:111], v[84:87], v[64:79]
  buffer_load_dwordx4 v115, s[36:39], s71 offen lds
  v_exp_f32 v18, v18
  s_add_u32 m0, s70, 1024
  v_exp_f32 v19, v19
  buffer_load_dwordx4 v116, s[40:43], s71 offen lds
  s_add_u32 s71, s71, 114688
  s_waitcnt vmcnt(3)
  ds_read_b64_tr_b16 v[200:201], v114 offset:2048
  ds_read_b64_tr_b16 v[202:203], v114 offset:2304
  v_exp_f32 v20, v20
  ds_read_b128 v[92:95], v112 offset:19456
  s_mov_b64 exec, s[72:73]
  ds_read_b128 v[104:107], v113 offset:19456
  ds_read_b128 v[108:111], v113 offset:19968
  s_mov_b64 exec, -1
  v_exp_f32 v21, v21
  v_mfma_f32_32x32x16_bf16 v[32:47], v[88:91], v[12:15], 0
  v_exp_f32 v22, v22
  v_exp_f32 v23, v23
  v_cvt_pk_bf16_f32 v80, v16, v17
  v_cvt_pk_bf16_f32 v81, v18, v19
  v_cvt_pk_bf16_f32 v82, v20, v21
  v_cvt_pk_bf16_f32 v83, v22, v23
  v_exp_f32 v24, v24
  v_exp_f32 v25, v25
  v_mfma_f32_32x32x16_bf16 v[48:63], v[96:99], v[80:83], v[48:63]
  v_exp_f32 v26, v26
  v_exp_f32 v27, v27
  v_exp_f32 v28, v28
  v_exp_f32 v29, v29
  v_exp_f32 v30, v30
  v_exp_f32 v31, v31
  v_cvt_pk_bf16_f32 v84, v24, v25
  v_cvt_pk_bf16_f32 v85, v26, v27
  v_cvt_pk_bf16_f32 v86, v28, v29
  v_cvt_pk_bf16_f32 v87, v30, v31
  v_exp_f32 v32, v32
  v_exp_f32 v33, v33
  v_mfma_f32_32x32x16_bf16 v[48:63], v[100:103], v[84:87], v[48:63]
  v_exp_f32 v34, v34
  v_exp_f32 v35, v35
  v_exp_f32 v36, v36
  v_exp_f32 v37, v37
  s_waitcnt lgkmcnt(0)
  v_mfma_f32_32x32x16_bf16 v[16:31], v[92:95], v[8:11], 0
  v_exp_f32 v38, v38
  v_exp_f32 v39, v39
  v_cvt_pk_bf16_f32 v80, v32, v33
  v_cvt_pk_bf16_f32 v81, v34, v35
  v_cvt_pk_bf16_f32 v82, v36, v37
  v_cvt_pk_bf16_f32 v83, v38, v39
  v_exp_f32 v40, v40
  v_exp_f32 v41, v41
  v_mfma_f32_32x32x16_bf16 v[64:79], v[96:99], v[80:83], v[64:79]
  v_exp_f32 v42, v42
  v_exp_f32 v43, v43
  v_exp_f32 v44, v44
  v_exp_f32 v45, v45
  v_exp_f32 v46, v46
  v_exp_f32 v47, v47
  v_cvt_pk_bf16_f32 v84, v40, v41
  v_cvt_pk_bf16_f32 v85, v42, v43
  v_cvt_pk_bf16_f32 v86, v44, v45
  v_cvt_pk_bf16_f32 v87, v46, v47
  v_exp_f32 v16, v16
  v_exp_f32 v17, v17
  v_mfma_f32_32x32x16_bf16 v[64:79], v[100:103], v[84:87], v[64:79]
  v_exp_f32 v18, v18
  v_exp_f32 v19, v19
  ds_read_b64_tr_b16 v[204:205], v114 offset:2560
  ds_read_b64_tr_b16 v[206:207], v114 offset:2816
  v_exp_f32 v20, v20
  ds_read_b128 v[88:91], v112 offset:20480
  s_mov_b64 exec, s[72:73]
  ds_read_b128 v[96:99], v113 offset:20480
  ds_read_b128 v[100:103], v113 offset:20992
  s_mov_b64 exec, -1
  v_exp_f32 v21, v21
  v_mfma_f32_32x32x16_bf16 v[32:47], v[92:95], v[12:15], 0
  v_exp_f32 v22, v22
  v_exp_f32 v23, v23
  v_cvt_pk_bf16_f32 v80, v16, v17
  v_cvt_pk_bf16_f32 v81, v18, v19
  v_cvt_pk_bf16_f32 v82, v20, v21
  v_cvt_pk_bf16_f32 v83, v22, v23
  v_exp_f32 v24, v24
  v_exp_f32 v25, v25
  v_mfma_f32_32x32x16_bf16 v[48:63], v[104:107], v[80:83], v[48:63]
  v_exp_f32 v26, v26
  v_exp_f32 v27, v27
  v_exp_f32 v28, v28
  v_exp_f32 v29, v29
  v_exp_f32 v30, v30
  v_exp_f32 v31, v31
  v_cvt_pk_bf16_f32 v84, v24, v25
  v_cvt_pk_bf16_f32 v85, v26, v27
  v_cvt_pk_bf16_f32 v86, v28, v29
  v_cvt_pk_bf16_f32 v87, v30, v31
  v_exp_f32 v32, v32
  v_exp_f32 v33, v33
  v_mfma_f32_32x32x16_bf16 v[48:63], v[108:111], v[84:87], v[48:63]
  v_exp_f32 v34, v34
  v_exp_f32 v35, v35
  v_exp_f32 v36, v36
  v_exp_f32 v37, v37
  s_waitcnt lgkmcnt(0)
  v_mfma_f32_32x32x16_bf16 v[16:31], v[88:91], v[8:11], 0
  v_exp_f32 v38, v38
  v_exp_f32 v39, v39
  v_cvt_pk_bf16_f32 v80, v32, v33
  v_cvt_pk_bf16_f32 v81, v34, v35
  v_cvt_pk_bf16_f32 v82, v36, v37
  v_cvt_pk_bf16_f32 v83, v38, v39
  v_exp_f32 v40, v40
  v_exp_f32 v41, v41
  v_mfma_f32_32x32x16_bf16 v[64:79], v[104:107], v[80:83], v[64:79]
  v_exp_f32 v42, v42
  v_exp_f32 v43, v43
  v_exp_f32 v44, v44
  v_exp_f32 v45, v45
  v_exp_f32 v46, v46
  v_exp_f32 v47, v47
  v_cvt_pk_bf16_f32 v84, v40, v41
  v_cvt_pk_bf16_f32 v85, v42, v43
  v_cvt_pk_bf16_f32 v86, v44, v45
  v_cvt_pk_bf16_f32 v87, v46, v47
  v_exp_f32 v16, v16
  s_add_u32 m0, s70, 2048
  v_exp_f32 v17, v17
  v_mfma_f32_32x32x16_bf16 v[64:79], v[108:111], v[84:87], v[64:79]
  buffer_load_dwordx4 v115, s[36:39], s71 offen lds
  v_exp_f32 v18, v18
  s_add_u32 m0, s70, 3072
  v_exp_f32 v19, v19
  buffer_load_dwordx4 v116, s[40:43], s71 offen lds
  s_add_u32 s71, s71, 114688
  s_waitcnt vmcnt(2)
  ds_read_b64_tr_b16 v[208:209], v114 offset:0
  ds_read_b64_tr_b16 v[210:211], v114 offset:256
  v_exp_f32 v20, v20
  ds_read_b128 v[92:95], v112 offset:21504
  s_mov_b64 exec, s[72:73]
  ds_read_b128 v[104:107], v113 offset:21504
  ds_read_b128 v[108:111], v113 offset:22016
  s_mov_b64 exec, -1
  v_exp_f32 v21, v21
  v_mfma_f32_32x32x16_bf16 v[32:47], v[88:91], v[12:15], 0
  v_exp_f32 v22, v22
  v_exp_f32 v23, v23
  v_cvt_pk_bf16_f32 v80, v16, v17
  v_cvt_pk_bf16_f32 v81, v18, v19
  v_cvt_pk_bf16_f32 v82, v20, v21
  v_cvt_pk_bf16_f32 v83, v22, v23
  v_exp_f32 v24, v24
  v_exp_f32 v25, v25
  v_mfma_f32_32x32x16_bf16 v[48:63], v[96:99], v[80:83], v[48:63]
  v_exp_f32 v26, v26
  v_exp_f32 v27, v27
  v_exp_f32 v28, v28
  v_exp_f32 v29, v29
  s_add_u32 s57, s84, 229376
  s_mov_b64 exec, 0xff
  buffer_load_dword v117, v119, s[32:35], s57 offen
  s_mov_b64 exec, -1
  v_exp_f32 v30, v30
  v_exp_f32 v31, v31
  v_cvt_pk_bf16_f32 v84, v24, v25
  v_cvt_pk_bf16_f32 v85, v26, v27
  v_cvt_pk_bf16_f32 v86, v28, v29
  v_cvt_pk_bf16_f32 v87, v30, v31
  v_exp_f32 v32, v32
  v_exp_f32 v33, v33
  v_mfma_f32_32x32x16_bf16 v[48:63], v[100:103], v[84:87], v[48:63]
  v_exp_f32 v34, v34
  v_exp_f32 v35, v35
  v_exp_f32 v36, v36
  v_exp_f32 v37, v37
  s_waitcnt lgkmcnt(0)
  v_mfma_f32_32x32x16_bf16 v[16:31], v[92:95], v[8:11], 0
  v_exp_f32 v38, v38
  v_exp_f32 v39, v39
  v_cvt_pk_bf16_f32 v80, v32, v33
  v_cvt_pk_bf16_f32 v81, v34, v35
  v_cvt_pk_bf16_f32 v82, v36, v37
  v_cvt_pk_bf16_f32 v83, v38, v39
  v_exp_f32 v40, v40
  v_exp_f32 v41, v41
  v_mfma_f32_32x32x16_bf16 v[64:79], v[96:99], v[80:83], v[64:79]
  v_exp_f32 v42, v42
  v_exp_f32 v43, v43
  v_exp_f32 v44, v44
  v_exp_f32 v45, v45
  v_exp_f32 v46, v46
  v_exp_f32 v47, v47
  v_cvt_pk_bf16_f32 v84, v40, v41
  v_cvt_pk_bf16_f32 v85, v42, v43
  v_cvt_pk_bf16_f32 v86, v44, v45
  v_cvt_pk_bf16_f32 v87, v46, v47
  v_exp_f32 v16, v16
  v_exp_f32 v17, v17
  v_mfma_f32_32x32x16_bf16 v[64:79], v[100:103], v[84:87], v[64:79]
  v_exp_f32 v18, v18
  v_exp_f32 v19, v19
  ds_read_b64_tr_b16 v[212:213], v114 offset:512
  ds_read_b64_tr_b16 v[214:215], v114 offset:768
  v_exp_f32 v20, v20
  ds_read_b128 v[88:91], v112 offset:22528
  s_mov_b64 exec, s[72:73]
  ds_read_b128 v[96:99], v113 offset:22528
  ds_read_b128 v[100:103], v113 offset:23040
  s_mov_b64 exec, -1
  v_exp_f32 v21, v21
  v_mfma_f32_32x32x16_bf16 v[32:47], v[92:95], v[12:15], 0
  v_exp_f32 v22, v22
  v_exp_f32 v23, v23
  v_cvt_pk_bf16_f32 v80, v16, v17
  v_cvt_pk_bf16_f32 v81, v18, v19
  v_cvt_pk_bf16_f32 v82, v20, v21
  v_cvt_pk_bf16_f32 v83, v22, v23
  v_exp_f32 v24, v24
  v_exp_f32 v25, v25
  v_mfma_f32_32x32x16_bf16 v[48:63], v[104:107], v[80:83], v[48:63]
  v_exp_f32 v26, v26
  v_exp_f32 v27, v27
  v_exp_f32 v28, v28
  v_exp_f32 v29, v29
  v_exp_f32 v30, v30
  v_exp_f32 v31, v31
  v_cvt_pk_bf16_f32 v84, v24, v25
  v_cvt_pk_bf16_f32 v85, v26, v27
  v_cvt_pk_bf16_f32 v86, v28, v29
  v_cvt_pk_bf16_f32 v87, v30, v31
  v_exp_f32 v32, v32
  v_exp_f32 v33, v33
  v_mfma_f32_32x32x16_bf16 v[48:63], v[108:111], v[84:87], v[48:63]
  v_exp_f32 v34, v34
  v_exp_f32 v35, v35
  v_exp_f32 v36, v36
  v_exp_f32 v37, v37
  s_waitcnt lgkmcnt(0)
  v_mfma_f32_32x32x16_bf16 v[16:31], v[88:91], v[8:11], 0
  v_exp_f32 v38, v38
  v_exp_f32 v39, v39
  v_cvt_pk_bf16_f32 v80, v32, v33
  v_cvt_pk_bf16_f32 v81, v34, v35
  v_cvt_pk_bf16_f32 v82, v36, v37
  v_cvt_pk_bf16_f32 v83, v38, v39
  v_exp_f32 v40, v40
  v_exp_f32 v41, v41
  v_mfma_f32_32x32x16_bf16 v[64:79], v[104:107], v[80:83], v[64:79]
  v_exp_f32 v42, v42
  v_exp_f32 v43, v43
  v_exp_f32 v44, v44
  v_exp_f32 v45, v45
  v_exp_f32 v46, v46
  v_exp_f32 v47, v47
  v_cvt_pk_bf16_f32 v84, v40, v41
  v_cvt_pk_bf16_f32 v85, v42, v43
  v_cvt_pk_bf16_f32 v86, v44, v45
  v_cvt_pk_bf16_f32 v87, v46, v47
  s_setprio 1
  v_exp_f32 v16, v16
  s_add_u32 m0, s70, 0
  v_exp_f32 v17, v17
  v_mfma_f32_32x32x16_bf16 v[64:79], v[108:111], v[84:87], v[64:79]
  buffer_load_dwordx4 v115, s[36:39], s71 offen lds
  v_exp_f32 v18, v18
  s_add_u32 m0, s70, 1024
  v_exp_f32 v19, v19
  buffer_load_dwordx4 v116, s[40:43], s71 offen lds
  s_add_u32 s71, s71, 114688
  s_waitcnt vmcnt(3)
  ds_read_b64_tr_b16 v[216:217], v114 offset:2048
  ds_read_b64_tr_b16 v[218:219], v114 offset:2304
  v_exp_f32 v20, v20
  ds_read_b128 v[92:95], v112 offset:23552
  s_mov_b64 exec, s[72:73]
  ds_read_b128 v[104:107], v113 offset:23552
  ds_read_b128 v[108:111], v113 offset:24064
  s_mov_b64 exec, -1
  v_exp_f32 v21, v21
  v_mfma_f32_32x32x16_bf16 v[32:47], v[88:91], v[12:15], 0
  v_exp_f32 v22, v22
  v_exp_f32 v23, v23
  v_cvt_pk_bf16_f32 v80, v16, v17
  v_cvt_pk_bf16_f32 v81, v18, v19
  v_cvt_pk_bf16_f32 v82, v20, v21
  v_cvt_pk_bf16_f32 v83, v22, v23
  v_exp_f32 v24, v24
  v_exp_f32 v25, v25
  v_mfma_f32_32x32x16_bf16 v[48:63], v[96:99], v[80:83], v[48:63]
  v_exp_f32 v26, v26
  v_exp_f32 v27, v27
  v_exp_f32 v28, v28
  v_exp_f32 v29, v29
  v_exp_f32 v30, v30
  v_exp_f32 v31, v31
  v_cvt_pk_bf16_f32 v84, v24, v25
  v_cvt_pk_bf16_f32 v85, v26, v27
  v_cvt_pk_bf16_f32 v86, v28, v29
  v_cvt_pk_bf16_f32 v87, v30, v31
  v_exp_f32 v32, v32
  v_exp_f32 v33, v33
  v_mfma_f32_32x32x16_bf16 v[48:63], v[100:103], v[84:87], v[48:63]
  v_exp_f32 v34, v34
  v_exp_f32 v35, v35
  v_exp_f32 v36, v36
  v_exp_f32 v37, v37
  s_waitcnt lgkmcnt(0)
  v_mfma_f32_32x32x16_bf16 v[16:31], v[92:95], v[8:11], 0
  v_exp_f32 v38, v38
  v_exp_f32 v39, v39
  v_cvt_pk_bf16_f32 v80, v32, v33
  v_cvt_pk_bf16_f32 v81, v34, v35
  v_cvt_pk_bf16_f32 v82, v36, v37
  v_cvt_pk_bf16_f32 v83, v38, v39
  v_exp_f32 v40, v40
  v_exp_f32 v41, v41
  v_mfma_f32_32x32x16_bf16 v[64:79], v[96:99], v[80:83], v[64:79]
  v_exp_f32 v42, v42
  v_exp_f32 v43, v43
  v_exp_f32 v44, v44
  v_exp_f32 v45, v45
  v_exp_f32 v46, v46
  v_exp_f32 v47, v47
  v_cvt_pk_bf16_f32 v84, v40, v41
  v_cvt_pk_bf16_f32 v85, v42, v43
  v_cvt_pk_bf16_f32 v86, v44, v45
  v_cvt_pk_bf16_f32 v87, v46, v47
  v_exp_f32 v16, v16
  v_exp_f32 v17, v17
  v_mfma_f32_32x32x16_bf16 v[64:79], v[100:103], v[84:87], v[64:79]
  v_exp_f32 v18, v18
  v_exp_f32 v19, v19
  ds_read_b64_tr_b16 v[220:221], v114 offset:2560
  ds_read_b64_tr_b16 v[222:223], v114 offset:2816
  v_exp_f32 v20, v20
  ds_read_b128 v[88:91], v112 offset:24576
  s_mov_b64 exec, s[72:73]
  ds_read_b128 v[96:99], v113 offset:24576
  ds_read_b128 v[100:103], v113 offset:25088
  s_mov_b64 exec, -1
  v_exp_f32 v21, v21
  v_mfma_f32_32x32x16_bf16 v[32:47], v[92:95], v[12:15], 0
  v_exp_f32 v22, v22
  v_exp_f32 v23, v23
  v_cvt_pk_bf16_f32 v80, v16, v17
  v_cvt_pk_bf16_f32 v81, v18, v19
  v_cvt_pk_bf16_f32 v82, v20, v21
  v_cvt_pk_bf16_f32 v83, v22, v23
  v_exp_f32 v24, v24
  v_exp_f32 v25, v25
  v_mfma_f32_32x32x16_bf16 v[48:63], v[104:107], v[80:83], v[48:63]
  v_exp_f32 v26, v26
  v_exp_f32 v27, v27
  v_exp_f32 v28, v28
  v_exp_f32 v29, v29
  v_exp_f32 v30, v30
  v_exp_f32 v31, v31
  v_cvt_pk_bf16_f32 v84, v24, v25
  v_cvt_pk_bf16_f32 v85, v26, v27
  v_cvt_pk_bf16_f32 v86, v28, v29
  v_cvt_pk_bf16_f32 v87, v30, v31
  v_exp_f32 v32, v32
  v_exp_f32 v33, v33
  v_mfma_f32_32x32x16_bf16 v[48:63], v[108:111], v[84:87], v[48:63]
  v_exp_f32 v34, v34
  v_exp_f32 v35, v35
  v_exp_f32 v36, v36
  v_exp_f32 v37, v37
  s_waitcnt lgkmcnt(0)
  v_mfma_f32_32x32x16_bf16 v[16:31], v[88:91], v[8:11], 0
  v_exp_f32 v38, v38
  v_exp_f32 v39, v39
  v_cvt_pk_bf16_f32 v80, v32, v33
  v_cvt_pk_bf16_f32 v81, v34, v35
  v_cvt_pk_bf16_f32 v82, v36, v37
  v_cvt_pk_bf16_f32 v83, v38, v39
  v_exp_f32 v40, v40
  v_exp_f32 v41, v41
  v_mfma_f32_32x32x16_bf16 v[64:79], v[104:107], v[80:83], v[64:79]
  v_exp_f32 v42, v42
  v_exp_f32 v43, v43
  v_exp_f32 v44, v44
  v_exp_f32 v45, v45
  v_exp_f32 v46, v46
  v_exp_f32 v47, v47
  v_cvt_pk_bf16_f32 v84, v40, v41
  v_cvt_pk_bf16_f32 v85, v42, v43
  v_cvt_pk_bf16_f32 v86, v44, v45
  v_cvt_pk_bf16_f32 v87, v46, v47
  v_exp_f32 v16, v16
  s_add_u32 m0, s70, 2048
  v_exp_f32 v17, v17
  v_mfma_f32_32x32x16_bf16 v[64:79], v[108:111], v[84:87], v[64:79]
  buffer_load_dwordx4 v115, s[36:39], s71 offen lds
  v_exp_f32 v18, v18
  s_add_u32 m0, s70, 3072
  v_exp_f32 v19, v19
  buffer_load_dwordx4 v116, s[40:43], s71 offen lds
  s_add_u32 s71, s71, 114688
  s_waitcnt vmcnt(2)
  ds_read_b64_tr_b16 v[224:225], v114 offset:0
  ds_read_b64_tr_b16 v[226:227], v114 offset:256
  v_exp_f32 v20, v20
  ds_read_b128 v[92:95], v112 offset:25600
  s_mov_b64 exec, s[72:73]
  ds_read_b128 v[104:107], v113 offset:25600
  ds_read_b128 v[108:111], v113 offset:26112
  s_mov_b64 exec, -1
  v_exp_f32 v21, v21
  v_mfma_f32_32x32x16_bf16 v[32:47], v[88:91], v[12:15], 0
  v_exp_f32 v22, v22
  v_exp_f32 v23, v23
  v_cvt_pk_bf16_f32 v80, v16, v17
  v_cvt_pk_bf16_f32 v81, v18, v19
  v_cvt_pk_bf16_f32 v82, v20, v21
  v_cvt_pk_bf16_f32 v83, v22, v23
  v_exp_f32 v24, v24
  v_exp_f32 v25, v25
  v_mfma_f32_32x32x16_bf16 v[48:63], v[96:99], v[80:83], v[48:63]
  v_exp_f32 v26, v26
  v_exp_f32 v27, v27
  v_exp_f32 v28, v28
  v_exp_f32 v29, v29
  s_add_u32 s57, s84, 344064
  s_mov_b64 exec, 0xff
  buffer_load_dword v117, v119, s[32:35], s57 offen
  s_mov_b64 exec, -1
  v_exp_f32 v30, v30
  v_exp_f32 v31, v31
  v_cvt_pk_bf16_f32 v84, v24, v25
  v_cvt_pk_bf16_f32 v85, v26, v27
  v_cvt_pk_bf16_f32 v86, v28, v29
  v_cvt_pk_bf16_f32 v87, v30, v31
  v_exp_f32 v32, v32
  v_exp_f32 v33, v33
  v_mfma_f32_32x32x16_bf16 v[48:63], v[100:103], v[84:87], v[48:63]
  v_exp_f32 v34, v34
  v_exp_f32 v35, v35
  v_exp_f32 v36, v36
  v_exp_f32 v37, v37
  s_waitcnt lgkmcnt(0)
  v_mfma_f32_32x32x16_bf16 v[16:31], v[92:95], v[8:11], 0
  v_exp_f32 v38, v38
  v_exp_f32 v39, v39
  v_cvt_pk_bf16_f32 v80, v32, v33
  v_cvt_pk_bf16_f32 v81, v34, v35
  v_cvt_pk_bf16_f32 v82, v36, v37
  v_cvt_pk_bf16_f32 v83, v38, v39
  v_exp_f32 v40, v40
  v_exp_f32 v41, v41
  v_mfma_f32_32x32x16_bf16 v[64:79], v[96:99], v[80:83], v[64:79]
  v_exp_f32 v42, v42
  v_exp_f32 v43, v43
  v_exp_f32 v44, v44
  v_exp_f32 v45, v45
  v_exp_f32 v46, v46
  v_exp_f32 v47, v47
  v_cvt_pk_bf16_f32 v84, v40, v41
  v_cvt_pk_bf16_f32 v85, v42, v43
  v_cvt_pk_bf16_f32 v86, v44, v45
  v_cvt_pk_bf16_f32 v87, v46, v47
  v_exp_f32 v16, v16
  v_exp_f32 v17, v17
  v_mfma_f32_32x32x16_bf16 v[64:79], v[100:103], v[84:87], v[64:79]
  v_exp_f32 v18, v18
  v_exp_f32 v19, v19
  ds_read_b64_tr_b16 v[228:229], v114 offset:512
  ds_read_b64_tr_b16 v[230:231], v114 offset:768
  v_exp_f32 v20, v20
  ds_read_b128 v[88:91], v112 offset:26624
  s_mov_b64 exec, s[72:73]
  ds_read_b128 v[96:99], v113 offset:26624
  ds_read_b128 v[100:103], v113 offset:27136
  s_mov_b64 exec, -1
  v_exp_f32 v21, v21
  v_mfma_f32_32x32x16_bf16 v[32:47], v[92:95], v[12:15], 0
  v_exp_f32 v22, v22
  v_exp_f32 v23, v23
  v_cvt_pk_bf16_f32 v80, v16, v17
  v_cvt_pk_bf16_f32 v81, v18, v19
  v_cvt_pk_bf16_f32 v82, v20, v21
  v_cvt_pk_bf16_f32 v83, v22, v23
  v_exp_f32 v24, v24
  v_exp_f32 v25, v25
  v_mfma_f32_32x32x16_bf16 v[48:63], v[104:107], v[80:83], v[48:63]
  v_exp_f32 v26, v26
  v_exp_f32 v27, v27
  v_exp_f32 v28, v28
  v_exp_f32 v29, v29
  v_exp_f32 v30, v30
  v_exp_f32 v31, v31
  v_cvt_pk_bf16_f32 v84, v24, v25
  v_cvt_pk_bf16_f32 v85, v26, v27
  v_cvt_pk_bf16_f32 v86, v28, v29
  v_cvt_pk_bf16_f32 v87, v30, v31
  v_exp_f32 v32, v32
  v_exp_f32 v33, v33
  v_mfma_f32_32x32x16_bf16 v[48:63], v[108:111], v[84:87], v[48:63]
  v_exp_f32 v34, v34
  v_exp_f32 v35, v35
  v_exp_f32 v36, v36
  v_exp_f32 v37, v37
  s_waitcnt lgkmcnt(0)
  v_mfma_f32_32x32x16_bf16 v[16:31], v[88:91], v[8:11], 0
  v_exp_f32 v38, v38
  v_exp_f32 v39, v39
  v_cvt_pk_bf16_f32 v80, v32, v33
  v_cvt_pk_bf16_f32 v81, v34, v35
  v_cvt_pk_bf16_f32 v82, v36, v37
  v_cvt_pk_bf16_f32 v83, v38, v39
  v_exp_f32 v40, v40
  v_exp_f32 v41, v41
  v_mfma_f32_32x32x16_bf16 v[64:79], v[104:107], v[80:83], v[64:79]
  v_exp_f32 v42, v42
  v_exp_f32 v43, v43
  v_exp_f32 v44, v44
  v_exp_f32 v45, v45
  v_exp_f32 v46, v46
  v_exp_f32 v47, v47
  v_cvt_pk_bf16_f32 v84, v40, v41
  v_cvt_pk_bf16_f32 v85, v42, v43
  v_cvt_pk_bf16_f32 v86, v44, v45
  v_cvt_pk_bf16_f32 v87, v46, v47
  v_exp_f32 v16, v16
  s_add_u32 m0, s70, 0
  v_exp_f32 v17, v17
  v_mfma_f32_32x32x16_bf16 v[64:79], v[108:111], v[84:87], v[64:79]
  buffer_load_dwordx4 v115, s[36:39], s71 offen lds
  v_exp_f32 v18, v18
  s_add_u32 m0, s70, 1024
  v_exp_f32 v19, v19
  buffer_load_dwordx4 v116, s[40:43], s71 offen lds
  s_add_u32 s71, s71, 114688
  s_waitcnt vmcnt(3)
  ds_read_b64_tr_b16 v[232:233], v114 offset:2048
  ds_read_b64_tr_b16 v[234:235], v114 offset:2304
  v_exp_f32 v20, v20
  ds_read_b128 v[92:95], v112 offset:27648
  s_mov_b64 exec, s[72:73]
  ds_read_b128 v[104:107], v113 offset:27648
  ds_read_b128 v[108:111], v113 offset:28160
  s_mov_b64 exec, -1
  v_exp_f32 v21, v21
  v_mfma_f32_32x32x16_bf16 v[32:47], v[88:91], v[12:15], 0
  v_exp_f32 v22, v22
  v_exp_f32 v23, v23
  v_cvt_pk_bf16_f32 v80, v16, v17
  v_cvt_pk_bf16_f32 v81, v18, v19
  v_cvt_pk_bf16_f32 v82, v20, v21
  v_cvt_pk_bf16_f32 v83, v22, v23
  v_exp_f32 v24, v24
  v_exp_f32 v25, v25
  v_mfma_f32_32x32x16_bf16 v[48:63], v[96:99], v[80:83], v[48:63]
  v_exp_f32 v26, v26
  v_exp_f32 v27, v27
  v_exp_f32 v28, v28
  v_exp_f32 v29, v29
  v_exp_f32 v30, v30
  v_exp_f32 v31, v31
  v_cvt_pk_bf16_f32 v84, v24, v25
  v_cvt_pk_bf16_f32 v85, v26, v27
  v_cvt_pk_bf16_f32 v86, v28, v29
  v_cvt_pk_bf16_f32 v87, v30, v31
  v_exp_f32 v32, v32
  v_exp_f32 v33, v33
  v_mfma_f32_32x32x16_bf16 v[48:63], v[100:103], v[84:87], v[48:63]
  v_exp_f32 v34, v34
  v_exp_f32 v35, v35
  v_exp_f32 v36, v36
  v_exp_f32 v37, v37
  s_waitcnt lgkmcnt(0)
  v_mfma_f32_32x32x16_bf16 v[16:31], v[92:95], v[8:11], 0
  v_exp_f32 v38, v38
  v_exp_f32 v39, v39
  v_cvt_pk_bf16_f32 v80, v32, v33
  v_cvt_pk_bf16_f32 v81, v34, v35
  v_cvt_pk_bf16_f32 v82, v36, v37
  v_cvt_pk_bf16_f32 v83, v38, v39
  v_exp_f32 v40, v40
  v_exp_f32 v41, v41
  v_mfma_f32_32x32x16_bf16 v[64:79], v[96:99], v[80:83], v[64:79]
  v_exp_f32 v42, v42
  v_exp_f32 v43, v43
  v_exp_f32 v44, v44
  v_exp_f32 v45, v45
  v_exp_f32 v46, v46
  v_exp_f32 v47, v47
  v_cvt_pk_bf16_f32 v84, v40, v41
  v_cvt_pk_bf16_f32 v85, v42, v43
  v_cvt_pk_bf16_f32 v86, v44, v45
  v_cvt_pk_bf16_f32 v87, v46, v47
  v_exp_f32 v16, v16
  v_exp_f32 v17, v17
  v_mfma_f32_32x32x16_bf16 v[64:79], v[100:103], v[84:87], v[64:79]
  v_exp_f32 v18, v18
  v_exp_f32 v19, v19
  ds_read_b64_tr_b16 v[236:237], v114 offset:2560
  ds_read_b64_tr_b16 v[238:239], v114 offset:2816
  v_exp_f32 v20, v20
  ds_read_b128 v[88:91], v112 offset:28672
  s_mov_b64 exec, s[72:73]
  ds_read_b128 v[96:99], v113 offset:28672
  ds_read_b128 v[100:103], v113 offset:29184
  s_mov_b64 exec, -1
  v_exp_f32 v21, v21
  v_mfma_f32_32x32x16_bf16 v[32:47], v[92:95], v[12:15], 0
  v_exp_f32 v22, v22
  v_exp_f32 v23, v23
  v_cvt_pk_bf16_f32 v80, v16, v17
  v_cvt_pk_bf16_f32 v81, v18, v19
  v_cvt_pk_bf16_f32 v82, v20, v21
  v_cvt_pk_bf16_f32 v83, v22, v23
  v_exp_f32 v24, v24
  v_exp_f32 v25, v25
  v_mfma_f32_32x32x16_bf16 v[48:63], v[104:107], v[80:83], v[48:63]
  v_exp_f32 v26, v26
  v_exp_f32 v27, v27
  v_exp_f32 v28, v28
  v_exp_f32 v29, v29
  v_exp_f32 v30, v30
  v_exp_f32 v31, v31
  v_cvt_pk_bf16_f32 v84, v24, v25
  v_cvt_pk_bf16_f32 v85, v26, v27
  v_cvt_pk_bf16_f32 v86, v28, v29
  v_cvt_pk_bf16_f32 v87, v30, v31
  v_exp_f32 v32, v32
  v_exp_f32 v33, v33
  v_mfma_f32_32x32x16_bf16 v[48:63], v[108:111], v[84:87], v[48:63]
  v_exp_f32 v34, v34
  v_exp_f32 v35, v35
  v_exp_f32 v36, v36
  v_exp_f32 v37, v37
  s_waitcnt lgkmcnt(0)
  v_mfma_f32_32x32x16_bf16 v[16:31], v[88:91], v[8:11], 0
  v_exp_f32 v38, v38
  v_exp_f32 v39, v39
  v_cvt_pk_bf16_f32 v80, v32, v33
  v_cvt_pk_bf16_f32 v81, v34, v35
  v_cvt_pk_bf16_f32 v82, v36, v37
  v_cvt_pk_bf16_f32 v83, v38, v39
  v_exp_f32 v40, v40
  v_exp_f32 v41, v41
  v_mfma_f32_32x32x16_bf16 v[64:79], v[104:107], v[80:83], v[64:79]
  v_exp_f32 v42, v42
  v_exp_f32 v43, v43
  v_exp_f32 v44, v44
  v_exp_f32 v45, v45
  v_exp_f32 v46, v46
  v_exp_f32 v47, v47
  v_cvt_pk_bf16_f32 v84, v40, v41
  v_cvt_pk_bf16_f32 v85, v42, v43
  v_cvt_pk_bf16_f32 v86, v44, v45
  v_cvt_pk_bf16_f32 v87, v46, v47
  v_exp_f32 v16, v16
  s_add_u32 m0, s70, 2048
  v_exp_f32 v17, v17
  v_mfma_f32_32x32x16_bf16 v[64:79], v[108:111], v[84:87], v[64:79]
  buffer_load_dwordx4 v115, s[36:39], s71 offen lds
  v_exp_f32 v18, v18
  s_add_u32 m0, s70, 3072
  v_exp_f32 v19, v19
  buffer_load_dwordx4 v116, s[40:43], s71 offen lds
  s_add_u32 s71, s71, 114688
  s_waitcnt vmcnt(2)
  ds_read_b64_tr_b16 v[240:241], v114 offset:0
  ds_read_b64_tr_b16 v[242:243], v114 offset:256
  v_exp_f32 v20, v20
  ds_read_b128 v[92:95], v112 offset:29696
  s_mov_b64 exec, s[72:73]
  ds_read_b128 v[104:107], v113 offset:29696
  ds_read_b128 v[108:111], v113 offset:30208
  s_mov_b64 exec, -1
  v_exp_f32 v21, v21
  v_mfma_f32_32x32x16_bf16 v[32:47], v[88:91], v[12:15], 0
  v_exp_f32 v22, v22
  v_exp_f32 v23, v23
  v_cvt_pk_bf16_f32 v80, v16, v17
  v_cvt_pk_bf16_f32 v81, v18, v19
  v_cvt_pk_bf16_f32 v82, v20, v21
  v_cvt_pk_bf16_f32 v83, v22, v23
  v_exp_f32 v24, v24
  v_exp_f32 v25, v25
  v_mfma_f32_32x32x16_bf16 v[48:63], v[96:99], v[80:83], v[48:63]
  v_exp_f32 v26, v26
  v_exp_f32 v27, v27
  v_exp_f32 v28, v28
  v_exp_f32 v29, v29
  v_exp_f32 v30, v30
  v_exp_f32 v31, v31
  v_cvt_pk_bf16_f32 v84, v24, v25
  v_cvt_pk_bf16_f32 v85, v26, v27
  v_cvt_pk_bf16_f32 v86, v28, v29
  v_cvt_pk_bf16_f32 v87, v30, v31
  v_exp_f32 v32, v32
  v_exp_f32 v33, v33
  v_mfma_f32_32x32x16_bf16 v[48:63], v[100:103], v[84:87], v[48:63]
  v_exp_f32 v34, v34
  v_exp_f32 v35, v35
  v_exp_f32 v36, v36
  v_exp_f32 v37, v37
  s_waitcnt lgkmcnt(0)
  v_mfma_f32_32x32x16_bf16 v[16:31], v[92:95], v[8:11], 0
  v_exp_f32 v38, v38
  v_exp_f32 v39, v39
  v_cvt_pk_bf16_f32 v80, v32, v33
  v_cvt_pk_bf16_f32 v81, v34, v35
  v_cvt_pk_bf16_f32 v82, v36, v37
  v_cvt_pk_bf16_f32 v83, v38, v39
  v_exp_f32 v40, v40
  v_exp_f32 v41, v41
  v_mfma_f32_32x32x16_bf16 v[64:79], v[96:99], v[80:83], v[64:79]
  v_exp_f32 v42, v42
  v_exp_f32 v43, v43
  v_exp_f32 v44, v44
  v_exp_f32 v45, v45
  v_exp_f32 v46, v46
  v_exp_f32 v47, v47
  v_cvt_pk_bf16_f32 v84, v40, v41
  v_cvt_pk_bf16_f32 v85, v42, v43
  v_cvt_pk_bf16_f32 v86, v44, v45
  v_cvt_pk_bf16_f32 v87, v46, v47
  s_setprio 0
  v_exp_f32 v16, v16
  v_exp_f32 v17, v17
  v_mfma_f32_32x32x16_bf16 v[64:79], v[100:103], v[84:87], v[64:79]
  v_exp_f32 v18, v18
  v_exp_f32 v19, v19
  ds_read_b64_tr_b16 v[244:245], v114 offset:512
  ds_read_b64_tr_b16 v[246:247], v114 offset:768
  v_exp_f32 v20, v20
  ds_read_b128 v[88:91], v112 offset:30720
  s_mov_b64 exec, s[72:73]
  ds_read_b128 v[96:99], v113 offset:30720
  ds_read_b128 v[100:103], v113 offset:31232
  s_mov_b64 exec, -1
  v_exp_f32 v21, v21
  v_mfma_f32_32x32x16_bf16 v[32:47], v[92:95], v[12:15], 0
  v_exp_f32 v22, v22
  v_exp_f32 v23, v23
  v_cvt_pk_bf16_f32 v80, v16, v17
  v_cvt_pk_bf16_f32 v81, v18, v19
  v_cvt_pk_bf16_f32 v82, v20, v21
  v_cvt_pk_bf16_f32 v83, v22, v23
  v_exp_f32 v24, v24
  v_exp_f32 v25, v25
  v_mfma_f32_32x32x16_bf16 v[48:63], v[104:107], v[80:83], v[48:63]
  v_exp_f32 v26, v26
  v_exp_f32 v27, v27
  v_exp_f32 v28, v28
  v_exp_f32 v29, v29
  v_exp_f32 v30, v30
  v_exp_f32 v31, v31
  v_cvt_pk_bf16_f32 v84, v24, v25
  v_cvt_pk_bf16_f32 v85, v26, v27
  v_cvt_pk_bf16_f32 v86, v28, v29
  v_cvt_pk_bf16_f32 v87, v30, v31
  v_exp_f32 v32, v32
  v_exp_f32 v33, v33
  v_mfma_f32_32x32x16_bf16 v[48:63], v[108:111], v[84:87], v[48:63]
  v_exp_f32 v34, v34
  v_exp_f32 v35, v35
  v_exp_f32 v36, v36
  v_exp_f32 v37, v37
  s_waitcnt lgkmcnt(0)
  v_mfma_f32_32x32x16_bf16 v[16:31], v[88:91], v[8:11], 0
  v_exp_f32 v38, v38
  v_exp_f32 v39, v39
  v_cvt_pk_bf16_f32 v80, v32, v33
  v_cvt_pk_bf16_f32 v81, v34, v35
  v_cvt_pk_bf16_f32 v82, v36, v37
  v_cvt_pk_bf16_f32 v83, v38, v39
  v_exp_f32 v40, v40
  v_exp_f32 v41, v41
  v_mfma_f32_32x32x16_bf16 v[64:79], v[104:107], v[80:83], v[64:79]
  v_exp_f32 v42, v42
  v_exp_f32 v43, v43
  v_exp_f32 v44, v44
  v_exp_f32 v45, v45
  v_exp_f32 v46, v46
  v_exp_f32 v47, v47
  v_cvt_pk_bf16_f32 v84, v40, v41
  v_cvt_pk_bf16_f32 v85, v42, v43
  v_cvt_pk_bf16_f32 v86, v44, v45
  v_cvt_pk_bf16_f32 v87, v46, v47
  v_exp_f32 v16, v16
  v_exp_f32 v17, v17
  v_mfma_f32_32x32x16_bf16 v[64:79], v[108:111], v[84:87], v[64:79]
  v_exp_f32 v18, v18
  v_exp_f32 v19, v19
  s_waitcnt vmcnt(0)
  ds_read_b64_tr_b16 v[248:249], v114 offset:2048
  ds_read_b64_tr_b16 v[250:251], v114 offset:2304
  v_exp_f32 v20, v20
  ds_read_b128 v[92:95], v112 offset:31744
  s_mov_b64 exec, s[72:73]
  ds_read_b128 v[104:107], v113 offset:31744
  ds_read_b128 v[108:111], v113 offset:32256
  s_mov_b64 exec, -1
  v_exp_f32 v21, v21
  v_mfma_f32_32x32x16_bf16 v[32:47], v[88:91], v[12:15], 0
  v_exp_f32 v22, v22
  v_exp_f32 v23, v23
  v_cvt_pk_bf16_f32 v80, v16, v17
  v_cvt_pk_bf16_f32 v81, v18, v19
  v_cvt_pk_bf16_f32 v82, v20, v21
  v_cvt_pk_bf16_f32 v83, v22, v23
  v_exp_f32 v24, v24
  v_exp_f32 v25, v25
  v_mfma_f32_32x32x16_bf16 v[48:63], v[96:99], v[80:83], v[48:63]
  v_exp_f32 v26, v26
  v_exp_f32 v27, v27
  v_exp_f32 v28, v28
  s_mov_b32 s44, s22
  s_mov_b32 s45, s23
  s_mov_b32 s46, 1024
  s_mov_b32 s47, 0x20000
  v_lshlrev_b32 v2, 1, v0
  buffer_load_ushort v124, v2, s[44:47], 0 offen
  s_mov_b32 s44, s24
  s_mov_b32 s45, s25
  s_mov_b32 s46, 3145728
  v_mul_u32_u24 v2, 6144, v0
  s_lshl_b32 s54, s90, 9
  s_lshr_b32 s55, s2, 3
  s_lshl_b32 s55, s55, 4
  s_add_u32 s54, s54, s55
  s_add_u32 s54, s54, 2048
  buffer_load_dwordx4 v[120:123], v2, s[44:47], s54 offen
  v_exp_f32 v29, v29
  v_exp_f32 v30, v30
  v_exp_f32 v31, v31
  v_cvt_pk_bf16_f32 v84, v24, v25
  v_cvt_pk_bf16_f32 v85, v26, v27
  v_cvt_pk_bf16_f32 v86, v28, v29
  v_cvt_pk_bf16_f32 v87, v30, v31
  v_exp_f32 v32, v32
  v_exp_f32 v33, v33
  v_mfma_f32_32x32x16_bf16 v[48:63], v[100:103], v[84:87], v[48:63]
  v_exp_f32 v34, v34
  s_mov_b32 s44, s4
  s_mov_b32 s45, s5
  s_mov_b32 s46, 2097152
  s_mov_b32 s47, 0x20000
  s_lshl_b32 s54, s48, 7
  s_lshl_b32 s55, s50, 6
  s_add_u32 s54, s54, s55
  s_lshl_b32 s55, s95, 5
  s_add_u32 s54, s54, s55
  v_and_b32 v2, 31, v1
  v_add_u32 v2, s54, v2
  v_lshlrev_b32 v2, 10, v2
  v_lshrrev_b32 v3, 5, v1
  v_lshlrev_b32 v3, 3, v3
  s_lshl_b32 s54, s51, 7
  s_lshl_b32 s55, s87, 5
  s_add_u32 s54, s54, s55
  v_add3_u32 v2, v2, v3, s54
  buffer_load_dwordx2 v[116:117], v2, s[44:47], 0 offen
  buffer_load_dwordx2 v[118:119], v2, s[44:47], 0 offen offset:16
  v_exp_f32 v35, v35
  v_exp_f32 v36, v36
  v_exp_f32 v37, v37
  s_waitcnt lgkmcnt(0)
  v_mfma_f32_32x32x16_bf16 v[16:31], v[92:95], v[8:11], 0
  v_exp_f32 v38, v38
  v_exp_f32 v39, v39
  v_cvt_pk_bf16_f32 v80, v32, v33
  v_cvt_pk_bf16_f32 v81, v34, v35
  v_cvt_pk_bf16_f32 v82, v36, v37
  v_cvt_pk_bf16_f32 v83, v38, v39
  v_exp_f32 v40, v40
  v_exp_f32 v41, v41
  v_mfma_f32_32x32x16_bf16 v[64:79], v[96:99], v[80:83], v[64:79]
  v_exp_f32 v42, v42
  v_exp_f32 v43, v43
  v_exp_f32 v44, v44
  v_exp_f32 v45, v45
  v_exp_f32 v46, v46
  v_exp_f32 v47, v47
  v_cvt_pk_bf16_f32 v84, v40, v41
  v_cvt_pk_bf16_f32 v85, v42, v43
  v_cvt_pk_bf16_f32 v86, v44, v45
  v_cvt_pk_bf16_f32 v87, v46, v47
  v_exp_f32 v16, v16
  v_exp_f32 v17, v17
  v_mfma_f32_32x32x16_bf16 v[64:79], v[100:103], v[84:87], v[64:79]
  v_exp_f32 v18, v18
  v_exp_f32 v19, v19
  ds_read_b64_tr_b16 v[252:253], v114 offset:2560
  ds_read_b64_tr_b16 v[254:255], v114 offset:2816
  v_exp_f32 v20, v20
  v_exp_f32 v21, v21
  v_mfma_f32_32x32x16_bf16 v[32:47], v[92:95], v[12:15], 0
  v_exp_f32 v22, v22
  v_exp_f32 v23, v23
  v_cvt_pk_bf16_f32 v80, v16, v17
  v_cvt_pk_bf16_f32 v81, v18, v19
  v_cvt_pk_bf16_f32 v82, v20, v21
  v_cvt_pk_bf16_f32 v83, v22, v23
  v_exp_f32 v24, v24
  v_exp_f32 v25, v25
  v_mfma_f32_32x32x16_bf16 v[48:63], v[104:107], v[80:83], v[48:63]
  v_exp_f32 v26, v26
  v_exp_f32 v27, v27
  v_exp_f32 v28, v28
  v_exp_f32 v29, v29
  v_exp_f32 v30, v30
  v_exp_f32 v31, v31
  v_cvt_pk_bf16_f32 v84, v24, v25
  v_cvt_pk_bf16_f32 v85, v26, v27
  v_cvt_pk_bf16_f32 v86, v28, v29
  v_cvt_pk_bf16_f32 v87, v30, v31
  v_exp_f32 v32, v32
  v_exp_f32 v33, v33
  v_mfma_f32_32x32x16_bf16 v[48:63], v[108:111], v[84:87], v[48:63]
  v_exp_f32 v34, v34
  v_exp_f32 v35, v35
  v_exp_f32 v36, v36
  v_exp_f32 v37, v37
  v_exp_f32 v38, v38
  v_exp_f32 v39, v39
  v_cvt_pk_bf16_f32 v80, v32, v33
  v_cvt_pk_bf16_f32 v81, v34, v35
  v_cvt_pk_bf16_f32 v82, v36, v37
  v_cvt_pk_bf16_f32 v83, v38, v39
  v_exp_f32 v40, v40
  v_exp_f32 v41, v41
  v_mfma_f32_32x32x16_bf16 v[64:79], v[104:107], v[80:83], v[64:79]
  v_exp_f32 v42, v42
  v_exp_f32 v43, v43
  v_exp_f32 v44, v44
  v_exp_f32 v45, v45
  v_exp_f32 v46, v46
  v_exp_f32 v47, v47
  v_cvt_pk_bf16_f32 v84, v40, v41
  v_cvt_pk_bf16_f32 v85, v42, v43
  v_cvt_pk_bf16_f32 v86, v44, v45
  v_cvt_pk_bf16_f32 v87, v46, v47
  s_nop 1
  v_mfma_f32_32x32x16_bf16 v[64:79], v[108:111], v[84:87], v[64:79]
  s_waitcnt lgkmcnt(0)
  s_setprio 0
  s_mov_b32 s93, 0
L_fin:
  s_cmp_lg_u32 s52, 0
  s_cbranch_scc1 L_badz_39
  v_mov_b32 v6, 134656
  v_mov_b32 v7, 0
  ds_write_b32 v6, v7
L_badz_39:
  v_lshlrev_b32 v2, 4, v1
  v_add_u32 v3, s70, v2
  s_xor_b32 s54, s52, 4
  s_lshl_b32 s54, s54, 12
  s_add_u32 s54, s54, 131072
  v_add_u32 v4, s54, v2
  s_cmp_ge_u32 s52, 4
  s_cbranch_scc1 L_s1_40
  ds_write_b128 v3, v[64:67]
  ds_write_b128 v3, v[68:71] offset:1024
  ds_write_b128 v3, v[72:75] offset:2048
  s_branch L_sj_41
L_s1_40:
  ds_write_b128 v3, v[48:51]
  ds_write_b128 v3, v[52:55] offset:1024
  ds_write_b128 v3, v[56:59] offset:2048
  v_mov_b32 v48, v64
  v_mov_b32 v49, v65
  v_mov_b32 v50, v66
  v_mov_b32 v51, v67
  v_mov_b32 v52, v68
  v_mov_b32 v53, v69
  v_mov_b32 v54, v70
  v_mov_b32 v55, v71
  v_mov_b32 v56, v72
L_sj_41:
  s_waitcnt lgkmcnt(0)
  s_barrier
  ds_read_b128 v[16:19], v4
  ds_read_b128 v[20:23], v4 offset:1024
  ds_read_b128 v[24:27], v4 offset:2048
  s_waitcnt lgkmcnt(0)
  v_add_f32 v48, v48, v16
  v_add_f32 v49, v49, v17
  v_add_f32 v50, v50, v18
  v_add_f32 v51, v51, v19
  v_add_f32 v52, v52, v20
  v_add_f32 v53, v53, v21
  v_add_f32 v54, v54, v22
  v_add_f32 v55, v55, v23
  v_add_f32 v56, v56, v24
  v_mov_b32 v16, v56
  v_mov_b32 v17, v56
  s_nop 1
  v_permlane32_swap_b32 v16, v17
  v_rcp_f32 v17, v16
  s_nop 0
  v_mul_f32 v48, v48, v17
  v_mul_f32 v49, v49, v17
  v_mul_f32 v50, v50, v17
  v_mul_f32 v51, v51, v17
  v_mul_f32 v52, v52, v17
  v_mul_f32 v53, v53, v17
  v_mul_f32 v54, v54, v17
  v_mul_f32 v55, v55, v17
  v_cvt_pk_bf16_f32 v20, v48, v49
  v_cvt_pk_bf16_f32 v21, v50, v51
  v_cvt_pk_bf16_f32 v22, v52, v53
  v_cvt_pk_bf16_f32 v23, v54, v55
  s_cmp_eq_u32 s3, 1
  s_cbranch_scc1 L_stf_42
  buffer_store_dwordx4 v[20:23], v2, s[32:35], s82 offen sc1
  s_branch L_stj_43
L_stf_42:
  buffer_store_dwordx4 v[20:23], v2, s[32:35], s82 offen
L_stj_43:
  v_add_f32 v18, |v48|, |v49|
  v_add_f32 v18, v18, |v50|
  v_add_f32 v18, v18, |v51|
  v_add_f32 v18, v18, |v52|
  v_add_f32 v18, v18, |v53|
  v_add_f32 v18, v18, |v54|
  v_add_f32 v18, v18, |v55|
  s_mov_b32 s54, 0x30800000
  s_mov_b32 s55, 0x5d800000
  s_mov_b32 s56, 0x7e800000
  v_cmp_nge_f32 vcc, v16, s54
  v_cmp_nle_f32 s[96:97], v16, s55
  s_or_b64 vcc, vcc, s[96:97]
  v_cmp_nlt_f32 s[96:97], v18, s56
  s_or_b64 vcc, vcc, s[96:97]
  s_cbranch_vccz L_lok_44
  v_mov_b32 v18, 134656
  v_mov_b32 v19, 1
  ds_write_b32 v18, v19
L_lok_44:
  s_lshl_b32 s58, s48, 8
  s_add_u32 s58, s58, 90112
  s_lshl_b32 s63, s50, 7
  s_add_u32 s58, s58, s63
  s_lshl_b32 s54, s51, 2
  s_add_u32 s59, s58, s54
  s_waitcnt vmcnt(0)
  s_waitcnt lgkmcnt(0)
  s_barrier
  v_mov_b32 v2, 134656
  ds_read_b32 v3, v2
  s_waitcnt lgkmcnt(0)
  v_readfirstlane_b32 s54, v3
  s_sub_u32 s54, s54, s93
  s_cmp_eq_u32 s54, 1
  s_cbranch_scc1 L_slow
  s_cmp_lg_u32 s52, 0
  s_cbranch_scc1 L_flag_45
  s_mov_b64 exec, 1
  v_mov_b32 v2, s59
  v_mov_b32 v3, s53
  s_cmp_eq_u32 s3, 1
  s_cbranch_scc1 L_stf_46
  buffer_store_dword v3, v2, s[32:35], 0 offen sc1
  s_branch L_stj_47
L_stf_46:
  buffer_store_dword v3, v2, s[32:35], 0 offen
L_stj_47:
  s_mov_b64 exec, -1
L_flag_45:
  s_lshl_b32 s74, s51, 6
  s_lshl_b32 s54, s87, 4
  s_add_u32 s74, s74, s54
  s_lshl_b32 s75, s50, 1
  s_add_u32 s75, s75, s95
  s_lshl_b32 s76, s48, 7
  s_lshl_b32 s54, s75, 5
  s_add_u32 s76, s76, s54
  s_mov_b32 s60, s12
  s_mov_b32 s61, s13
  s_mov_b32 s62, 524288
  s_mov_b32 s63, 0x20000
  v_lshrrev_b32 v2, 3, v1
  v_bfe_u32 v3, v2, 1, 1
  v_lshlrev_b32 v3, 2, v3
  v_and_b32 v126, 7, v1
  v_xor_b32 v3, v3, v126
  v_lshlrev_b32 v3, 4, v3
  s_lshl_b32 s54, s52, 6
  v_add_u32 v2, s54, v2
  v_lshlrev_b32 v2, 10, v2
  s_lshl_b32 s54, s51, 7
  v_add3_u32 v126, v3, v2, s54
  s_lshl_b32 s85, s87, 15
  s_lshl_b32 s54, s95, 13
  s_add_u32 s85, s85, s54
  s_add_u32 m0, s85, 0
  s_mov_b32 s57, 0
  buffer_load_dwordx4 v126, s[60:63], s57 offen lds
  s_add_u32 m0, s85, 1024
  s_mov_b32 s57, 8192
  buffer_load_dwordx4 v126, s[60:63], s57 offen lds
  s_add_u32 m0, s85, 2048
  s_mov_b32 s57, 16384
  buffer_load_dwordx4 v126, s[60:63], s57 offen lds
  s_add_u32 m0, s85, 3072
  s_mov_b32 s57, 24576
  buffer_load_dwordx4 v126, s[60:63], s57 offen lds
  s_add_u32 m0, s85, 4096
  s_mov_b32 s57, 32768
  buffer_load_dwordx4 v126, s[60:63], s57 offen lds
  s_add_u32 m0, s85, 5120
  s_mov_b32 s57, 40960
  buffer_load_dwordx4 v126, s[60:63], s57 offen lds
  s_add_u32 m0, s85, 6144
  s_mov_b32 s57, 49152
  buffer_load_dwordx4 v126, s[60:63], s57 offen lds
  s_add_u32 m0, s85, 7168
  s_mov_b32 s57, 57344
  buffer_load_dwordx4 v126, s[60:63], s57 offen lds
  v_lshlrev_b32 v124, 16, v124
  v_mul_f32 v125, 0xbfb8aa3b, v124
  v_exp_f32 v125, v125
  s_nop 0
  v_add_f32 v125, 1.0, v125
  v_rcp_f32 v125, v125
  s_nop 0
  v_mul_f32 v124, v124, v125
  v_cvt_pk_bf16_f32 v124, v124, 0
  v_lshlrev_b32 v125, 16, v124
  v_dot2_f32_bf16 v24, v120, v124, 0
  v_dot2_f32_bf16 v25, v120, v125, 0
  v_dot2_f32_bf16 v26, v121, v124, 0
  v_dot2_f32_bf16 v27, v121, v125, 0
  v_dot2_f32_bf16 v28, v122, v124, 0
  v_dot2_f32_bf16 v29, v122, v125, 0
  v_dot2_f32_bf16 v30, v123, v124, 0
  v_dot2_f32_bf16 v31, v123, v125, 0
  v_permlane32_swap_b32 v24, v28
  v_permlane32_swap_b32 v25, v29
  v_permlane32_swap_b32 v26, v30
  v_permlane32_swap_b32 v27, v31
  v_add_f32 v24, v24, v28
  v_add_f32 v25, v25, v29
  v_add_f32 v26, v26, v30
  v_add_f32 v27, v27, v31
  s_nop 0
  v_permlane16_swap_b32 v24, v26
  v_permlane16_swap_b32 v25, v27
  v_add_f32 v24, v24, v26
  v_add_f32 v25, v25, v27
  s_nop 0
  v_add_f32_dpp v24, v24, v24 row_ror:8 row_mask:0xf bank_mask:0xf
  v_add_f32_dpp v25, v25, v25 row_ror:8 row_mask:0xf bank_mask:0xf
  s_nop 0
  v_add_f32_dpp v24, v24, v24 row_ror:4 row_mask:0xf bank_mask:0xf
  v_add_f32_dpp v25, v25, v25 row_ror:4 row_mask:0xf bank_mask:0xf
  s_nop 0
  v_add_f32_dpp v24, v24, v24 row_ror:2 row_mask:0xf bank_mask:0xf
  v_add_f32_dpp v25, v25, v25 row_ror:2 row_mask:0xf bank_mask:0xf
  s_nop 0
  v_add_f32_dpp v24, v24, v24 row_ror:1 row_mask:0xf bank_mask:0xf
  v_add_f32_dpp v25, v25, v25 row_ror:1 row_mask:0xf bank_mask:0xf
  v_lshrrev_b32 v5, 4, v1
  v_lshlrev_b32 v4, 3, v5
  s_lshl_b32 s54, s52, 5
  s_add_u32 s54, s54, 131072
  v_add_u32 v4, s54, v4
  ds_write_b64 v4, v[24:25]
  s_waitcnt lgkmcnt(0)
  s_barrier
  s_cmp_lg_u32 s52, 7
  s_cbranch_scc1 L_mod2pub_48
  v_and_b32 v4, 3, v1
  v_lshlrev_b32 v4, 3, v4
  v_add_u32 v5, 131072, v4
  ds_read_b64 v[24:25], v5 offset:0
  ds_read_b64 v[26:27], v5 offset:32
  ds_read_b64 v[28:29], v5 offset:64
  ds_read_b64 v[30:31], v5 offset:96
  ds_read_b64 v[32:33], v5 offset:128
  ds_read_b64 v[34:35], v5 offset:160
  ds_read_b64 v[36:37], v5 offset:192
  ds_read_b64 v[38:39], v5 offset:224
  s_lshl_b32 s54, s90, 10
  s_lshr_b32 s55, s2, 3
  s_lshl_b32 s55, s55, 5
  s_add_u32 s54, s54, s55
  s_add_u32 s54, s54, 528384
  v_lshrrev_b32 v5, 2, v1
  v_mul_u32_u24 v5, 16384, v5
  v_add3_u32 v5, v5, v4, s54
  s_waitcnt lgkmcnt(0)
  v_add_f32 v24, v24, v26
  v_add_f32 v25, v25, v27
  v_add_f32 v24, v24, v28
  v_add_f32 v25, v25, v29
  v_add_f32 v24, v24, v30
  v_add_f32 v25, v25, v31
  v_add_f32 v24, v24, v32
  v_add_f32 v25, v25, v33
  v_add_f32 v24, v24, v34
  v_add_f32 v25, v25, v35
  v_add_f32 v24, v24, v36
  v_add_f32 v25, v25, v37
  v_add_f32 v24, v24, v38
  v_add_f32 v25, v25, v39
  v_cvt_pk_bf16_f32 v6, v24, v25
  v_mov_b32 v7, s53
  s_mov_b32 exec_hi, 0
  buffer_store_dwordx2 v[6:7], v5, s[32:35], 0 offen sc1
  s_mov_b64 exec, -1
L_mod2pub_48:
  s_cmp_lg_u32 s2, 0
  s_cbranch_scc1 L_epadv_49
  s_cmp_lg_u32 s52, 7
  s_cbranch_scc1 L_epadv_49
  v_lshlrev_b32 v2, 4, v1
  v_add_u32 v2, 1024, v2
  s_mov_b32 s86, 400000
L_poll_50:
  buffer_load_dwordx4 v[4:7], v2, s[32:35], 0 offen sc1
  s_waitcnt vmcnt(0)
  v_cmp_ne_u32 vcc, s53, v4
  v_cmp_ne_u32 s[96:97], s53, v5
  s_or_b64 vcc, vcc, s[96:97]
  v_cmp_ne_u32 s[96:97], s53, v6
  s_or_b64 vcc, vcc, s[96:97]
  v_cmp_ne_u32 s[96:97], s53, v7
  s_or_b64 vcc, vcc, s[96:97]
  s_sub_u32 s86, s86, 1
  s_cmp_eq_u32 s86, 0
  s_cbranch_scc1 L_pollout_51
  s_cbranch_vccnz L_poll_50
L_pollout_51:
  v_mov_b32 v2, 0
  v_mov_b32 v3, s53
  s_mov_b64 exec, 1
  buffer_store_dword v3, v2, s[32:35], 0 offen sc1
  s_mov_b64 exec, -1
L_epadv_49:
  s_waitcnt vmcnt(0)
  s_lshl_b32 s58, s48, 8
  s_add_u32 s58, s58, 90112
  s_lshl_b32 s63, s50, 7
  s_add_u32 s58, s58, s63
  s_cmp_lg_u32 s52, 0
  s_cbranch_scc1 L_fw_52
  s_mov_b64 exec, 255
  v_lshlrev_b32 v2, 2, v1
  v_add_u32 v2, s58, v2
  s_mov_b32 s86, 400000
L_poll_53:
  buffer_load_dword v4, v2, s[32:35], 0 offen sc1
  s_waitcnt vmcnt(0)
  v_cmp_ne_u32 vcc, s53, v4
  s_sub_u32 s86, s86, 1
  s_cmp_eq_u32 s86, 0
  s_cbranch_scc1 L_pollout_54
  s_cbranch_vccnz L_poll_53
L_pollout_54:
  s_mov_b64 exec, -1
L_fw_52:
  s_barrier
  s_lshl_b32 s54, s48, 2
  s_add_u32 s54, s54, s75
  s_lshl_b32 s54, s54, 5
  s_lshl_b32 s55, s87, 3
  s_add_u32 s54, s54, s55
  s_lshl_b32 s54, s54, 10
  s_add_u32 s54, s54, 1048576
  v_lshlrev_b32 v124, 4, v1
  buffer_load_dwordx4 v[72:75], v124, s[32:35], s54 offen sc1
  s_add_u32 s54, s54, 1024
  buffer_load_dwordx4 v[76:79], v124, s[32:35], s54 offen sc1
  s_add_u32 s54, s54, 1024
  buffer_load_dwordx4 v[104:107], v124, s[32:35], s54 offen sc1
  s_add_u32 s54, s54, 1024
  buffer_load_dwordx4 v[108:111], v124, s[32:35], s54 offen sc1
  s_add_u32 s54, s54, 1024
  buffer_load_dwordx4 v[112:115], v124, s[32:35], s54 offen sc1
  s_add_u32 s54, s54, 1024
  buffer_load_dwordx4 v[120:123], v124, s[32:35], s54 offen sc1
  s_add_u32 s54, s54, 1024
  buffer_load_dwordx4 v[8:11], v124, s[32:35], s54 offen sc1
  s_add_u32 s54, s54, 1024
  buffer_load_dwordx4 v[12:15], v124, s[32:35], s54 offen sc1
  s_mul_i32 s54, s90, 16384
  s_add_u32 s54, s54, 524288
  s_lshl_b32 s55, s74, 2
  s_add_u32 s54, s54, s55
  v_lshrrev_b32 v6, 5, v1
  v_lshlrev_b32 v6, 4, v6
  v_add_u32 v6, s54, v6
  s_mov_b32 s54, 4096
  buffer_load_dwordx4 v[80:83], v6, s[32:35], s54 offen sc1
  buffer_load_dwordx4 v[84:87], v6, s[32:35], s54 offen offset:32 sc1
  s_mov_b32 s54, 6144
  buffer_load_dwordx4 v[88:91], v6, s[32:35], s54 offen sc1
  buffer_load_dwordx4 v[92:95], v6, s[32:35], s54 offen offset:32 sc1
  s_mov_b32 s54, 8192
  buffer_load_dwordx4 v[96:99], v6, s[32:35], s54 offen sc1
  buffer_load_dwordx4 v[100:103], v6, s[32:35], s54 offen offset:32 sc1
  v_bfe_u32 v2, v1, 4, 1
  v_bfe_u32 v3, v1, 2, 2
  v_and_b32 v4, 3, v1
  v_lshrrev_b32 v5, 5, v1
  v_lshl_add_u32 v7, v5, 2, v3
  v_lshlrev_b32 v6, 1, v2
  v_lshrrev_b32 v5, 1, v4
  v_add_u32 v6, v6, v5
  v_lshrrev_b32 v5, 1, v3
  v_lshlrev_b32 v5, 2, v5
  v_xor_b32 v6, v6, v5
  v_lshlrev_b32 v6, 4, v6
  v_and_b32 v5, 1, v4
  v_lshl_add_u32 v6, v5, 3, v6
  v_lshl_add_u32 v125, v7, 7, v6
  s_lshl_b32 s54, s87, 15
  v_add_u32 v125, s54, v125
  v_xor_b32 v126, 64, v125
  ds_read_b64_tr_b16 v[48:49], v125 offset:0
  ds_read_b64_tr_b16 v[50:51], v125 offset:1024
  ds_read_b64_tr_b16 v[52:53], v126 offset:0
  ds_read_b64_tr_b16 v[54:55], v126 offset:1024
  ds_read_b64_tr_b16 v[56:57], v125 offset:2048
  ds_read_b64_tr_b16 v[58:59], v125 offset:3072
  ds_read_b64_tr_b16 v[60:61], v126 offset:2048
  ds_read_b64_tr_b16 v[62:63], v126 offset:3072
  ds_read_b64_tr_b16 v[64:65], v125 offset:4096
  ds_read_b64_tr_b16 v[66:67], v125 offset:5120
  ds_read_b64_tr_b16 v[68:69], v126 offset:4096
  ds_read_b64_tr_b16 v[70:71], v126 offset:5120
  s_waitcnt lgkmcnt(8)
  s_waitcnt vmcnt(13)
  v_mfma_f32_32x32x16_bf16 v[16:31], v[48:51], v[72:75], 0
  v_mfma_f32_32x32x16_bf16 v[32:47], v[52:55], v[72:75], 0
  ds_read_b64_tr_b16 v[48:49], v125 offset:6144
  ds_read_b64_tr_b16 v[50:51], v125 offset:7168
  ds_read_b64_tr_b16 v[52:53], v126 offset:6144
  ds_read_b64_tr_b16 v[54:55], v126 offset:7168
  s_waitcnt lgkmcnt(8)
  s_waitcnt vmcnt(12)
  v_mfma_f32_32x32x16_bf16 v[16:31], v[56:59], v[76:79], v[16:31]
  v_mfma_f32_32x32x16_bf16 v[32:47], v[60:63], v[76:79], v[32:47]
  ds_read_b64_tr_b16 v[56:57], v125 offset:8192
  ds_read_b64_tr_b16 v[58:59], v125 offset:9216
  ds_read_b64_tr_b16 v[60:61], v126 offset:8192
  ds_read_b64_tr_b16 v[62:63], v126 offset:9216
  s_waitcnt lgkmcnt(8)
  s_waitcnt vmcnt(11)
  v_mfma_f32_32x32x16_bf16 v[16:31], v[64:67], v[104:107], v[16:31]
  v_mfma_f32_32x32x16_bf16 v[32:47], v[68:71], v[104:107], v[32:47]
  ds_read_b64_tr_b16 v[64:65], v125 offset:10240
  ds_read_b64_tr_b16 v[66:67], v125 offset:11264
  ds_read_b64_tr_b16 v[68:69], v126 offset:10240
  ds_read_b64_tr_b16 v[70:71], v126 offset:11264
  s_waitcnt lgkmcnt(8)
  s_waitcnt vmcnt(10)
  v_mfma_f32_32x32x16_bf16 v[16:31], v[48:51], v[108:111], v[16:31]
  v_mfma_f32_32x32x16_bf16 v[32:47], v[52:55], v[108:111], v[32:47]
  ds_read_b64_tr_b16 v[48:49], v125 offset:12288
  ds_read_b64_tr_b16 v[50:51], v125 offset:13312
  ds_read_b64_tr_b16 v[52:53], v126 offset:12288
  ds_read_b64_tr_b16 v[54:55], v126 offset:13312
  s_waitcnt lgkmcnt(8)
  s_waitcnt vmcnt(9)
  v_mfma_f32_32x32x16_bf16 v[16:31], v[56:59], v[112:115], v[16:31]
  v_mfma_f32_32x32x16_bf16 v[32:47], v[60:63], v[112:115], v[32:47]
  ds_read_b64_tr_b16 v[56:57], v125 offset:14336
  ds_read_b64_tr_b16 v[58:59], v125 offset:15360
  ds_read_b64_tr_b16 v[60:61], v126 offset:14336
  ds_read_b64_tr_b16 v[62:63], v126 offset:15360
  s_waitcnt lgkmcnt(8)
  s_waitcnt vmcnt(8)
  v_mfma_f32_32x32x16_bf16 v[16:31], v[64:67], v[120:123], v[16:31]
  v_mfma_f32_32x32x16_bf16 v[32:47], v[68:71], v[120:123], v[32:47]
  s_waitcnt lgkmcnt(4)
  s_waitcnt vmcnt(7)
  v_mfma_f32_32x32x16_bf16 v[16:31], v[48:51], v[8:11], v[16:31]
  v_mfma_f32_32x32x16_bf16 v[32:47], v[52:55], v[8:11], v[32:47]
  s_waitcnt lgkmcnt(0)
  s_waitcnt vmcnt(6)
  v_mfma_f32_32x32x16_bf16 v[16:31], v[56:59], v[12:15], v[16:31]
  v_mfma_f32_32x32x16_bf16 v[32:47], v[60:63], v[12:15], v[32:47]
  v_lshlrev_b32 v64, 16, v116
  v_and_b32 v65, 0xffff0000, v116
  v_lshlrev_b32 v66, 16, v117
  v_and_b32 v67, 0xffff0000, v117
  v_lshlrev_b32 v68, 16, v118
  v_and_b32 v69, 0xffff0000, v118
  v_lshlrev_b32 v70, 16, v119
  v_and_b32 v71, 0xffff0000, v119
  s_mul_i32 s54, s95, 65536
  s_lshl_b32 s55, s87, 11
  s_add_u32 s54, s54, s55
  s_add_u32 s54, s54, 16384
  v_lshlrev_b32 v2, 4, v1
  v_add_u32 v3, s54, v2
  ds_write_b128 v3, v[16:19] offset:0
  ds_write_b128 v3, v[20:23] offset:1024
  ds_write_b128 v3, v[24:27] offset:8192
  ds_write_b128 v3, v[28:31] offset:9216
  ds_write_b128 v3, v[32:35] offset:32768
  ds_write_b128 v3, v[36:39] offset:33792
  ds_write_b128 v3, v[40:43] offset:40960
  ds_write_b128 v3, v[44:47] offset:41984
  s_mul_i32 s54, s95, 65536
  s_lshr_b32 s55, s87, 1
  s_mul_i32 s55, s55, 32768
  s_add_u32 s54, s54, s55
  s_and_b32 s55, s87, 1
  s_lshl_b32 s55, s55, 13
  s_add_u32 s54, s54, s55
  s_add_u32 s54, s54, 16384
  v_add_u32 v3, s54, v2
  s_waitcnt lgkmcnt(0)
  s_barrier
  ds_read_b128 v[16:19], v3 offset:0
  ds_read_b128 v[20:23], v3 offset:1024
  ds_read_b128 v[24:27], v3 offset:2048
  ds_read_b128 v[28:31], v3 offset:3072
  ds_read_b128 v[32:35], v3 offset:4096
  ds_read_b128 v[36:39], v3 offset:5120
  ds_read_b128 v[40:43], v3 offset:6144
  ds_read_b128 v[44:47], v3 offset:7168
  s_waitcnt lgkmcnt(4)
  v_add_f32 v48, v16, v24
  v_add_f32 v49, v17, v25
  v_add_f32 v50, v18, v26
  v_add_f32 v51, v19, v27
  v_add_f32 v52, v20, v28
  v_add_f32 v53, v21, v29
  v_add_f32 v54, v22, v30
  v_add_f32 v55, v23, v31
  s_waitcnt lgkmcnt(0)
  v_add_f32 v32, v32, v40
  v_add_f32 v33, v33, v41
  v_add_f32 v34, v34, v42
  v_add_f32 v35, v35, v43
  v_add_f32 v36, v36, v44
  v_add_f32 v37, v37, v45
  v_add_f32 v38, v38, v46
  v_add_f32 v39, v39, v47
  v_add_f32 v48, v48, v32
  v_add_f32 v49, v49, v33
  v_add_f32 v50, v50, v34
  v_add_f32 v51, v51, v35
  v_add_f32 v52, v52, v36
  v_add_f32 v53, v53, v37
  v_add_f32 v54, v54, v38
  v_add_f32 v55, v55, v39
  s_waitcnt vmcnt(0)
  s_mov_b32 s86, 400000
L_mv_55:
  v_cmp_ne_u32 vcc, s53, v81
  v_cmp_ne_u32 s[96:97], s53, v83
  s_or_b64 vcc, vcc, s[96:97]
  v_cmp_ne_u32 s[96:97], s53, v85
  s_or_b64 vcc, vcc, s[96:97]
  v_cmp_ne_u32 s[96:97], s53, v87
  s_or_b64 vcc, vcc, s[96:97]
  s_cbranch_vccz L_mvo_56
  s_sub_u32 s86, s86, 1
  s_cmp_eq_u32 s86, 0
  s_cbranch_scc1 L_mvo_56
  s_mul_i32 s54, s90, 16384
  s_add_u32 s54, s54, 524288
  s_lshl_b32 s55, s74, 2
  s_add_u32 s54, s54, s55
  v_lshrrev_b32 v6, 5, v1
  v_lshlrev_b32 v6, 4, v6
  v_add_u32 v6, s54, v6
  s_mov_b32 s54, 4096
  buffer_load_dwordx4 v[80:83], v6, s[32:35], s54 offen sc1
  buffer_load_dwordx4 v[84:87], v6, s[32:35], s54 offen offset:32 sc1
  s_waitcnt vmcnt(0)
  s_branch L_mv_55
L_mvo_56:
  v_lshlrev_b32 v56, 16, v80
  v_and_b32 v57, 0xffff0000, v80
  v_lshlrev_b32 v58, 16, v82
  v_and_b32 v59, 0xffff0000, v82
  v_lshlrev_b32 v60, 16, v84
  v_and_b32 v61, 0xffff0000, v84
  v_lshlrev_b32 v62, 16, v86
  v_and_b32 v63, 0xffff0000, v86
  v_fma_f32 v104, v56, v48, v64
  v_fma_f32 v105, v57, v49, v65
  v_fma_f32 v106, v58, v50, v66
  v_fma_f32 v107, v59, v51, v67
  v_fma_f32 v108, v60, v52, v68
  v_fma_f32 v109, v61, v53, v69
  v_fma_f32 v110, v62, v54, v70
  v_fma_f32 v111, v63, v55, v71
  v_add_f32 v16, v104, v105
  v_mul_f32 v17, v104, v104
  v_add_f32 v16, v16, v106
  v_add_f32 v16, v16, v107
  v_add_f32 v16, v16, v108
  v_add_f32 v16, v16, v109
  v_add_f32 v16, v16, v110
  v_add_f32 v16, v16, v111
  v_fma_f32 v17, v105, v105, v17
  v_fma_f32 v17, v106, v106, v17
  v_fma_f32 v17, v107, v107, v17
  v_fma_f32 v17, v108, v108, v17
  v_fma_f32 v17, v109, v109, v17
  v_fma_f32 v17, v110, v110, v17
  v_fma_f32 v17, v111, v111, v17
  v_mov_b32 v18, v16
  v_mov_b32 v19, v17
  s_nop 1
  v_permlane32_swap_b32 v16, v18
  v_permlane32_swap_b32 v17, v19
  s_nop 1
  v_add_f32 v16, v16, v18
  v_add_f32 v17, v17, v19
  v_and_b32 v2, 31, v1
  v_lshlrev_b32 v2, 3, v2
  s_lshl_b32 s54, s95, 10
  s_add_u32 s54, s54, 131072
  v_add_u32 v2, s54, v2
  s_lshl_b32 s55, s87, 8
  v_add_u32 v3, s55, v2
  ds_write_b64 v3, v[16:17]
  s_waitcnt lgkmcnt(0)
  s_barrier
  ds_read_b64 v[18:19], v2 offset:0
  ds_read_b64 v[20:21], v2 offset:256
  ds_read_b64 v[22:23], v2 offset:512
  ds_read_b64 v[24:25], v2 offset:768
  s_lshl_b32 s54, s48, 2
  s_add_u32 s54, s54, s75
  s_lshl_b32 s54, s54, 12
  s_add_u32 s56, s54, 131072
  s_lshl_b32 s55, s51, 9
  s_add_u32 s55, s55, s56
  v_and_b32 v2, 31, v1
  v_lshlrev_b32 v2, 4, v2
  s_waitcnt lgkmcnt(0)
  v_add_f32 v18, v18, v20
  v_add_f32 v19, v19, v21
  v_add_f32 v22, v22, v24
  v_add_f32 v23, v23, v25
  v_add_f32 v16, v18, v22
  v_mov_b32 v17, s53
  v_add_f32 v18, v19, v23
  v_mov_b32 v19, s53
  s_cmp_lg_u32 s87, 0
  s_cbranch_scc1 L_stpub_57
  s_mov_b32 exec_hi, 0
  s_cmp_eq_u32 s3, 1
  s_cbranch_scc1 L_stf_58
  buffer_store_dwordx4 v[16:19], v2, s[32:35], s55 offen sc1
  s_branch L_stj_59
L_stf_58:
  buffer_store_dwordx4 v[16:19], v2, s[32:35], s55 offen
L_stj_59:
  s_mov_b64 exec, -1
L_stpub_57:
  s_mov_b32 s86, 400000
L_mv_60:
  v_cmp_ne_u32 vcc, s53, v89
  v_cmp_ne_u32 s[96:97], s53, v91
  s_or_b64 vcc, vcc, s[96:97]
  v_cmp_ne_u32 s[96:97], s53, v93
  s_or_b64 vcc, vcc, s[96:97]
  v_cmp_ne_u32 s[96:97], s53, v95
  s_or_b64 vcc, vcc, s[96:97]
  v_cmp_ne_u32 s[96:97], s53, v97
  s_or_b64 vcc, vcc, s[96:97]
  v_cmp_ne_u32 s[96:97], s53, v99
  s_or_b64 vcc, vcc, s[96:97]
  v_cmp_ne_u32 s[96:97], s53, v101
  s_or_b64 vcc, vcc, s[96:97]
  v_cmp_ne_u32 s[96:97], s53, v103
  s_or_b64 vcc, vcc, s[96:97]
  s_cbranch_vccz L_mvo_61
  s_sub_u32 s86, s86, 1
  s_cmp_eq_u32 s86, 0
  s_cbranch_scc1 L_mvo_61
  s_mul_i32 s54, s90, 16384
  s_add_u32 s54, s54, 524288
  s_lshl_b32 s55, s74, 2
  s_add_u32 s54, s54, s55
  v_lshrrev_b32 v6, 5, v1
  v_lshlrev_b32 v6, 4, v6
  v_add_u32 v6, s54, v6
  s_mov_b32 s54, 6144
  buffer_load_dwordx4 v[88:91], v6, s[32:35], s54 offen sc1
  buffer_load_dwordx4 v[92:95], v6, s[32:35], s54 offen offset:32 sc1
  s_mov_b32 s54, 8192
  buffer_load_dwordx4 v[96:99], v6, s[32:35], s54 offen sc1
  buffer_load_dwordx4 v[100:103], v6, s[32:35], s54 offen offset:32 sc1
  s_waitcnt vmcnt(0)
  s_branch L_mv_60
L_mvo_61:
  v_lshlrev_b32 v64, 16, v88
  v_and_b32 v65, 0xffff0000, v88
  v_lshlrev_b32 v66, 16, v90
  v_and_b32 v67, 0xffff0000, v90
  v_lshlrev_b32 v68, 16, v92
  v_and_b32 v69, 0xffff0000, v92
  v_lshlrev_b32 v70, 16, v94
  v_and_b32 v71, 0xffff0000, v94
  v_lshlrev_b32 v72, 16, v96
  v_and_b32 v73, 0xffff0000, v96
  v_lshlrev_b32 v74, 16, v98
  v_and_b32 v75, 0xffff0000, v98
  v_lshlrev_b32 v76, 16, v100
  v_and_b32 v77, 0xffff0000, v100
  v_lshlrev_b32 v78, 16, v102
  v_and_b32 v79, 0xffff0000, v102
  v_add_f32 v72, 1.0, v72
  v_add_f32 v73, 1.0, v73
  v_add_f32 v74, 1.0, v74
  v_add_f32 v75, 1.0, v75
  v_add_f32 v76, 1.0, v76
  v_add_f32 v77, 1.0, v77
  v_add_f32 v78, 1.0, v78
  v_add_f32 v79, 1.0, v79
  v_cvt_pk_bf16_f32 v88, v72, v73
  v_cvt_pk_bf16_f32 v89, v74, v75
  v_cvt_pk_bf16_f32 v90, v76, v77
  v_cvt_pk_bf16_f32 v91, v78, v79
  v_lshlrev_b32 v72, 16, v88
  v_and_b32 v73, 0xffff0000, v88
  v_lshlrev_b32 v74, 16, v89
  v_and_b32 v75, 0xffff0000, v89
  v_lshlrev_b32 v76, 16, v90
  v_and_b32 v77, 0xffff0000, v90
  v_lshlrev_b32 v78, 16, v91
  v_and_b32 v79, 0xffff0000, v91
  v_lshrrev_b32 v3, 5, v1
  v_lshl_add_u32 v3, v3, 11, v2
  v_add_u32 v3, s56, v3
  s_mov_b32 s86, 400000
L_poll_62:
  buffer_load_dwordx4 v[20:23], v3, s[32:35], 0 offen offset:0 sc1
  buffer_load_dwordx4 v[24:27], v3, s[32:35], 0 offen offset:512 sc1
  buffer_load_dwordx4 v[28:31], v3, s[32:35], 0 offen offset:1024 sc1
  buffer_load_dwordx4 v[32:35], v3, s[32:35], 0 offen offset:1536 sc1
  s_waitcnt vmcnt(0)
  v_cmp_ne_u32 vcc, s53, v21
  v_cmp_ne_u32 s[96:97], s53, v23
  s_or_b64 vcc, vcc, s[96:97]
  v_cmp_ne_u32 s[96:97], s53, v25
  s_or_b64 vcc, vcc, s[96:97]
  v_cmp_ne_u32 s[96:97], s53, v27
  s_or_b64 vcc, vcc, s[96:97]
  v_cmp_ne_u32 s[96:97], s53, v29
  s_or_b64 vcc, vcc, s[96:97]
  v_cmp_ne_u32 s[96:97], s53, v31
  s_or_b64 vcc, vcc, s[96:97]
  v_cmp_ne_u32 s[96:97], s53, v33
  s_or_b64 vcc, vcc, s[96:97]
  v_cmp_ne_u32 s[96:97], s53, v35
  s_or_b64 vcc, vcc, s[96:97]
  s_sub_u32 s86, s86, 1
  s_cmp_eq_u32 s86, 0
  s_cbranch_scc1 L_pollout_63
  s_cbranch_vccnz L_poll_62
L_pollout_63:
  v_add_f32 v16, v20, v24
  v_add_f32 v17, v22, v26
  v_add_f32 v18, v28, v32
  v_add_f32 v19, v30, v34
  v_add_f32 v16, v16, v18
  v_add_f32 v17, v17, v19
  v_mov_b32 v18, v16
  v_mov_b32 v19, v17
  s_nop 1
  v_permlane32_swap_b32 v16, v18
  v_permlane32_swap_b32 v17, v19
  s_nop 1
  v_add_f32 v16, v16, v18
  v_add_f32 v17, v17, v19
  v_mul_f32 v16, 0x3b000000, v16
  v_mul_f32 v17, 0x3b000000, v17
  v_fma_f32 v17, -v16, v16, v17
  v_max_f32 v17, 0, v17
  v_add_f32 v17, 0x3727c5ac, v17
  v_rsq_f32 v17, v17
  v_sub_f32 v20, v104, v16
  v_sub_f32 v21, v105, v16
  v_sub_f32 v22, v106, v16
  v_sub_f32 v23, v107, v16
  v_sub_f32 v24, v108, v16
  v_sub_f32 v25, v109, v16
  v_sub_f32 v26, v110, v16
  v_sub_f32 v27, v111, v16
  v_mul_f32 v20, v20, v17
  v_mul_f32 v21, v21, v17
  v_mul_f32 v22, v22, v17
  v_mul_f32 v23, v23, v17
  v_mul_f32 v24, v24, v17
  v_mul_f32 v25, v25, v17
  v_mul_f32 v26, v26, v17
  v_mul_f32 v27, v27, v17
  v_fma_f32 v20, v20, v72, v64
  v_fma_f32 v21, v21, v73, v65
  v_fma_f32 v22, v22, v74, v66
  v_fma_f32 v23, v23, v75, v67
  v_fma_f32 v24, v24, v76, v68
  v_fma_f32 v25, v25, v77, v69
  v_fma_f32 v26, v26, v78, v70
  v_fma_f32 v27, v27, v79, v71
  v_cvt_pk_bf16_f32 v28, v20, v21
  v_cvt_pk_bf16_f32 v29, v22, v23
  v_cvt_pk_bf16_f32 v30, v24, v25
  v_cvt_pk_bf16_f32 v31, v26, v27
  v_lshlrev_b32 v2, 4, v1
  s_cmp_eq_u32 s3, 1
  s_cbranch_scc1 L_stf_64
  buffer_store_dwordx4 v[28:31], v2, s[32:35], s83 offen sc1
  s_branch L_stj_65
L_stf_64:
  buffer_store_dwordx4 v[28:31], v2, s[32:35], s83 offen
L_stj_65:
  s_lshl_b32 s58, s48, 7
  s_add_u32 s58, s58, 94208
  s_lshl_b32 s54, s49, 2
  s_add_u32 s59, s58, s54
  s_waitcnt vmcnt(0)
  s_barrier
  s_cmp_lg_u32 s52, 0
  s_cbranch_scc1 L_flag_66
  s_mov_b64 exec, 1
  v_mov_b32 v2, s59
  v_mov_b32 v3, s53
  s_cmp_eq_u32 s3, 1
  s_cbranch_scc1 L_stf_67
  buffer_store_dword v3, v2, s[32:35], 0 offen sc1
  s_branch L_stj_68
L_stf_67:
  buffer_store_dword v3, v2, s[32:35], 0 offen
L_stj_68:
  s_mov_b64 exec, -1
L_flag_66:
  s_mov_b32 s44, s20
  s_mov_b32 s45, s21
  s_mov_b32 s46, 1835008
  s_mov_b32 s47, 0x20000
  v_lshrrev_b32 v4, 3, v1
  v_bfe_u32 v6, v4, 1, 1
  v_lshlrev_b32 v6, 2, v6
  v_and_b32 v7, 7, v1
  v_xor_b32 v6, v6, v7
  v_lshlrev_b32 v6, 4, v6
  v_lshlrev_b32 v7, 10, v4
  s_lshl_b32 s54, s51, 7
  v_add3_u32 v122, v6, v7, s54
  s_mul_i32 s77, s87, 458752
  s_lshl_b32 s54, s95, 13
  s_add_u32 s77, s77, s54
  s_lshl_b32 s78, s52, 10
  s_cmp_ge_u32 s49, 14
  s_cbranch_scc1 L_noE_69
  s_add_u32 m0, s78, 131072
  s_add_u32 s62, s77, 0
  buffer_load_dwordx4 v122, s[44:47], s62 offen lds
  s_add_u32 m0, s78, 139264
  s_add_u32 s62, s77, 16384
  buffer_load_dwordx4 v122, s[44:47], s62 offen lds
  s_add_u32 m0, s78, 147456
  s_add_u32 s62, s77, 32768
  buffer_load_dwordx4 v122, s[44:47], s62 offen lds
  s_add_u32 m0, s78, 155648
  s_add_u32 s62, s77, 49152
  buffer_load_dwordx4 v122, s[44:47], s62 offen lds
  s_lshl_b32 s80, s48, 17
  s_add_u32 s80, s80, 3145728
  s_lshl_b32 s81, s52, 12
  s_add_u32 s80, s80, s81
  s_mul_i32 s79, s48, 458752
  s_lshl_b32 s54, s94, 3
  s_add_u32 s54, s54, s52
  s_lshl_b32 s54, s54, 10
  s_add_u32 s79, s79, s54
  s_add_u32 s79, s79, 5242880
  v_lshlrev_b32 v123, 4, v1
  v_add_u32 v121, 0x10000, v123
  s_lshl_b32 s58, s48, 7
  s_add_u32 s58, s58, 94208
  s_cmp_lg_u32 s52, 0
  s_cbranch_scc1 L_fw_71
  s_mov_b64 exec, 65535
  v_lshlrev_b32 v2, 2, v1
  v_add_u32 v2, s58, v2
  s_mov_b32 s86, 400000
L_poll_72:
  buffer_load_dword v4, v2, s[32:35], 0 offen sc1
  s_waitcnt vmcnt(0)
  v_cmp_ne_u32 vcc, s53, v4
  s_sub_u32 s86, s86, 1
  s_cmp_eq_u32 s86, 0
  s_cbranch_scc1 L_pollout_73
  s_cbranch_vccnz L_poll_72
L_pollout_73:
  s_mov_b64 exec, -1
L_fw_71:
  s_barrier
  s_add_u32 m0, s81, 0
  s_add_u32 s56, s80, 0
  buffer_load_dwordx4 v123, s[32:35], s56 offen sc1 lds
  s_add_u32 m0, s81, 1024
  s_add_u32 s56, s80, 1024
  buffer_load_dwordx4 v123, s[32:35], s56 offen sc1 lds
  s_add_u32 m0, s81, 2048
  s_add_u32 s56, s80, 2048
  buffer_load_dwordx4 v123, s[32:35], s56 offen sc1 lds
  s_add_u32 m0, s81, 3072
  s_add_u32 s56, s80, 3072
  buffer_load_dwordx4 v123, s[32:35], s56 offen sc1 lds
  s_lshl_b32 s82, s48, 11
  s_lshl_b32 s54, s94, 3
  s_add_u32 s54, s54, s52
  s_lshl_b32 s54, s54, 2
  s_add_u32 s82, s82, s54
  s_add_u32 s82, s82, 655360
  v_mov_b32 v88, 0
  v_mov_b32 v89, s53
  s_waitcnt vmcnt(0)
  s_barrier
.p2align 6
  s_nop 0
  ds_read_b128 v[48:51], v123 offset:0
  ds_read_b128 v[52:55], v123 offset:1024
  ds_read_b128 v[56:59], v123 offset:2048
  ds_read_b128 v[60:63], v123 offset:3072
  ds_read_b128 v[64:67], v123 offset:4096
  s_waitcnt lgkmcnt(4)
  v_mfma_f32_32x32x16_bf16 v[16:31], v[128:131], v[48:51], 0
  ds_read_b128 v[48:51], v123 offset:5120
  s_waitcnt lgkmcnt(4)
  v_mfma_f32_32x32x16_bf16 v[16:31], v[132:135], v[52:55], v[16:31]
  s_add_u32 m0, s81, 32768
  s_add_u32 s56, s80, 32768
  buffer_load_dwordx4 v123, s[32:35], s56 offen sc1 lds
  ds_read_b128 v[52:55], v123 offset:6144
  s_waitcnt lgkmcnt(4)
  v_mfma_f32_32x32x16_bf16 v[16:31], v[136:139], v[56:59], v[16:31]
  ds_read_b128 v[56:59], v123 offset:7168
  s_waitcnt lgkmcnt(4)
  v_mfma_f32_32x32x16_bf16 v[16:31], v[140:143], v[60:63], v[16:31]
  s_add_u32 m0, s81, 33792
  s_add_u32 s56, s80, 33792
  buffer_load_dwordx4 v123, s[32:35], s56 offen sc1 lds
  ds_read_b128 v[60:63], v123 offset:8192
  s_waitcnt lgkmcnt(4)
  v_mfma_f32_32x32x16_bf16 v[16:31], v[144:147], v[64:67], v[16:31]
  ds_read_b128 v[64:67], v123 offset:9216
  s_waitcnt lgkmcnt(4)
  v_mfma_f32_32x32x16_bf16 v[16:31], v[148:151], v[48:51], v[16:31]
  s_add_u32 m0, s81, 34816
  s_add_u32 s56, s80, 34816
  buffer_load_dwordx4 v123, s[32:35], s56 offen sc1 lds
  ds_read_b128 v[48:51], v123 offset:10240
  s_waitcnt lgkmcnt(4)
  v_mfma_f32_32x32x16_bf16 v[16:31], v[152:155], v[52:55], v[16:31]
  ds_read_b128 v[52:55], v123 offset:11264
  s_waitcnt lgkmcnt(4)
  v_mfma_f32_32x32x16_bf16 v[16:31], v[156:159], v[56:59], v[16:31]
  s_add_u32 m0, s81, 35840
  s_add_u32 s56, s80, 35840
  buffer_load_dwordx4 v123, s[32:35], s56 offen sc1 lds
  ds_read_b128 v[56:59], v123 offset:12288
  s_waitcnt lgkmcnt(4)
  v_mfma_f32_32x32x16_bf16 v[16:31], v[160:163], v[60:63], v[16:31]
  ds_read_b128 v[60:63], v123 offset:13312
  s_waitcnt lgkmcnt(4)
  v_mfma_f32_32x32x16_bf16 v[16:31], v[164:167], v[64:67], v[16:31]
  s_add_u32 m0, s81, 65536
  s_add_u32 s56, s80, 65536
  buffer_load_dwordx4 v123, s[32:35], s56 offen sc1 lds
  ds_read_b128 v[64:67], v123 offset:14336
  s_waitcnt lgkmcnt(4)
  v_mfma_f32_32x32x16_bf16 v[16:31], v[168:171], v[48:51], v[16:31]
  ds_read_b128 v[48:51], v123 offset:15360
  s_waitcnt lgkmcnt(4)
  v_mfma_f32_32x32x16_bf16 v[16:31], v[172:175], v[52:55], v[16:31]
  s_add_u32 m0, s81, 66560
  s_add_u32 s56, s80, 66560
  buffer_load_dwordx4 v123, s[32:35], s56 offen sc1 lds
  ds_read_b128 v[52:55], v123 offset:16384
  s_waitcnt lgkmcnt(4)
  v_mfma_f32_32x32x16_bf16 v[16:31], v[176:179], v[56:59], v[16:31]
  ds_read_b128 v[56:59], v123 offset:17408
  s_waitcnt lgkmcnt(4)
  v_mfma_f32_32x32x16_bf16 v[16:31], v[180:183], v[60:63], v[16:31]
  s_add_u32 m0, s81, 67584
  s_add_u32 s56, s80, 67584
  buffer_load_dwordx4 v123, s[32:35], s56 offen sc1 lds
  ds_read_b128 v[60:63], v123 offset:18432
  s_waitcnt lgkmcnt(4)
  v_mfma_f32_32x32x16_bf16 v[16:31], v[184:187], v[64:67], v[16:31]
  ds_read_b128 v[64:67], v123 offset:19456
  s_waitcnt lgkmcnt(4)
  v_mfma_f32_32x32x16_bf16 v[16:31], v[188:191], v[48:51], v[16:31]
  s_add_u32 m0, s81, 68608
  s_add_u32 s56, s80, 68608
  buffer_load_dwordx4 v123, s[32:35], s56 offen sc1 lds
  ds_read_b128 v[48:51], v123 offset:20480
  s_waitcnt lgkmcnt(4)
  v_mfma_f32_32x32x16_bf16 v[16:31], v[192:195], v[52:55], v[16:31]
  ds_read_b128 v[52:55], v123 offset:21504
  s_waitcnt lgkmcnt(4)
  v_mfma_f32_32x32x16_bf16 v[16:31], v[196:199], v[56:59], v[16:31]
  s_add_u32 m0, s81, 98304
  s_add_u32 s56, s80, 98304
  buffer_load_dwordx4 v123, s[32:35], s56 offen sc1 lds
  ds_read_b128 v[56:59], v123 offset:22528
  s_waitcnt lgkmcnt(4)
  v_mfma_f32_32x32x16_bf16 v[16:31], v[200:203], v[60:63], v[16:31]
  ds_read_b128 v[60:63], v123 offset:23552
  s_waitcnt lgkmcnt(4)
  v_mfma_f32_32x32x16_bf16 v[16:31], v[204:207], v[64:67], v[16:31]
  s_add_u32 m0, s81, 99328
  s_add_u32 s56, s80, 99328
  buffer_load_dwordx4 v123, s[32:35], s56 offen sc1 lds
  ds_read_b128 v[64:67], v123 offset:24576
  s_waitcnt lgkmcnt(4)
  v_mfma_f32_32x32x16_bf16 v[16:31], v[208:211], v[48:51], v[16:31]
  ds_read_b128 v[48:51], v123 offset:25600
  s_waitcnt lgkmcnt(4)
  v_mfma_f32_32x32x16_bf16 v[16:31], v[212:215], v[52:55], v[16:31]
  s_add_u32 m0, s81, 100352
  s_add_u32 s56, s80, 100352
  buffer_load_dwordx4 v123, s[32:35], s56 offen sc1 lds
  ds_read_b128 v[52:55], v123 offset:26624
  s_waitcnt lgkmcnt(4)
  v_mfma_f32_32x32x16_bf16 v[16:31], v[216:219], v[56:59], v[16:31]
  ds_read_b128 v[56:59], v123 offset:27648
  s_waitcnt lgkmcnt(4)
  v_mfma_f32_32x32x16_bf16 v[16:31], v[220:223], v[60:63], v[16:31]
  s_add_u32 m0, s81, 101376
  s_add_u32 s56, s80, 101376
  buffer_load_dwordx4 v123, s[32:35], s56 offen sc1 lds
  ds_read_b128 v[60:63], v123 offset:28672
  s_waitcnt lgkmcnt(4)
  v_mfma_f32_32x32x16_bf16 v[16:31], v[224:227], v[64:67], v[16:31]
  ds_read_b128 v[64:67], v123 offset:29696
  s_waitcnt lgkmcnt(4)
  v_mfma_f32_32x32x16_bf16 v[16:31], v[228:231], v[48:51], v[16:31]
  ds_read_b128 v[48:51], v123 offset:30720
  s_waitcnt lgkmcnt(4)
  v_mfma_f32_32x32x16_bf16 v[16:31], v[232:235], v[52:55], v[16:31]
  s_waitcnt vmcnt(8)
  s_barrier
  ds_read_b128 v[52:55], v123 offset:31744
  s_waitcnt lgkmcnt(4)
  v_mfma_f32_32x32x16_bf16 v[16:31], v[236:239], v[56:59], v[16:31]
  ds_read_b128 v[56:59], v123 offset:32768
  s_waitcnt lgkmcnt(4)
  v_mfma_f32_32x32x16_bf16 v[16:31], v[240:243], v[60:63], v[16:31]
  ds_read_b128 v[60:63], v123 offset:33792
  s_waitcnt lgkmcnt(4)
  v_mfma_f32_32x32x16_bf16 v[16:31], v[244:247], v[64:67], v[16:31]
  ds_read_b128 v[64:67], v123 offset:34816
  s_waitcnt lgkmcnt(4)
  v_mfma_f32_32x32x16_bf16 v[16:31], v[248:251], v[48:51], v[16:31]
  ds_read_b128 v[48:51], v123 offset:35840
  s_waitcnt lgkmcnt(4)
  v_mfma_f32_32x32x16_bf16 v[16:31], v[252:255], v[52:55], v[16:31]
  ds_read_b128 v[52:55], v123 offset:36864
  s_waitcnt lgkmcnt(4)
  v_mfma_f32_32x32x16_bf16 v[32:47], v[128:131], v[56:59], 0
  ds_read_b128 v[56:59], v123 offset:37888
  s_waitcnt lgkmcnt(4)
  v_mfma_f32_32x32x16_bf16 v[32:47], v[132:135], v[60:63], v[32:47]
  ds_read_b128 v[60:63], v123 offset:38912
  s_waitcnt lgkmcnt(4)
  v_mfma_f32_32x32x16_bf16 v[32:47], v[136:139], v[64:67], v[32:47]
  s_nop 2
  v_mul_f32 v76, 0xbfb8aa3b, v16
  v_mul_f32 v77, 0xbfb8aa3b, v17
  v_mul_f32 v78, 0xbfb8aa3b, v18
  ds_read_b128 v[64:67], v123 offset:39936
  s_waitcnt lgkmcnt(4)
  v_mfma_f32_32x32x16_bf16 v[32:47], v[140:143], v[48:51], v[32:47]
  v_mul_f32 v79, 0xbfb8aa3b, v19
  v_mul_f32 v80, 0xbfb8aa3b, v20
  v_mul_f32 v81, 0xbfb8aa3b, v21
  ds_read_b128 v[48:51], v123 offset:40960
  s_waitcnt lgkmcnt(4)
  v_mfma_f32_32x32x16_bf16 v[32:47], v[144:147], v[52:55], v[32:47]
  v_mul_f32 v82, 0xbfb8aa3b, v22
  v_mul_f32 v83, 0xbfb8aa3b, v23
  v_exp_f32 v76, v76
  ds_read_b128 v[52:55], v123 offset:41984
  s_waitcnt lgkmcnt(4)
  v_mfma_f32_32x32x16_bf16 v[32:47], v[148:151], v[56:59], v[32:47]
  v_exp_f32 v77, v77
  v_exp_f32 v78, v78
  v_exp_f32 v79, v79
  ds_read_b128 v[56:59], v123 offset:43008
  s_waitcnt lgkmcnt(4)
  v_mfma_f32_32x32x16_bf16 v[32:47], v[152:155], v[60:63], v[32:47]
  v_exp_f32 v80, v80
  v_exp_f32 v81, v81
  v_exp_f32 v82, v82
  ds_read_b128 v[60:63], v123 offset:44032
  s_waitcnt lgkmcnt(4)
  v_mfma_f32_32x32x16_bf16 v[32:47], v[156:159], v[64:67], v[32:47]
  v_exp_f32 v83, v83
  v_mul_f32 v16, v16, v24
  v_mul_f32 v17, v17, v25
  ds_read_b128 v[64:67], v123 offset:45056
  s_waitcnt lgkmcnt(4)
  v_mfma_f32_32x32x16_bf16 v[32:47], v[160:163], v[48:51], v[32:47]
  v_mul_f32 v18, v18, v26
  v_mul_f32 v19, v19, v27
  v_mul_f32 v20, v20, v28
  ds_read_b128 v[48:51], v123 offset:46080
  s_waitcnt lgkmcnt(4)
  v_mfma_f32_32x32x16_bf16 v[32:47], v[164:167], v[52:55], v[32:47]
  v_mul_f32 v21, v21, v29
  v_mul_f32 v22, v22, v30
  v_mul_f32 v23, v23, v31
  ds_read_b128 v[52:55], v123 offset:47104
  s_waitcnt lgkmcnt(4)
  v_mfma_f32_32x32x16_bf16 v[32:47], v[168:171], v[56:59], v[32:47]
  v_add_f32 v76, 1.0, v76
  v_add_f32 v77, 1.0, v77
  v_add_f32 v78, 1.0, v78
  ds_read_b128 v[56:59], v123 offset:48128
  s_waitcnt lgkmcnt(4)
  v_mfma_f32_32x32x16_bf16 v[32:47], v[172:175], v[60:63], v[32:47]
  v_add_f32 v79, 1.0, v79
  v_add_f32 v80, 1.0, v80
  v_add_f32 v81, 1.0, v81
  ds_read_b128 v[60:63], v123 offset:49152
  s_waitcnt lgkmcnt(4)
  v_mfma_f32_32x32x16_bf16 v[32:47], v[176:179], v[64:67], v[32:47]
  v_add_f32 v82, 1.0, v82
  v_add_f32 v83, 1.0, v83
  v_rcp_f32 v76, v76
  ds_read_b128 v[64:67], v123 offset:50176
  s_waitcnt lgkmcnt(4)
  v_mfma_f32_32x32x16_bf16 v[32:47], v[180:183], v[48:51], v[32:47]
  v_rcp_f32 v77, v77
  v_rcp_f32 v78, v78
  v_rcp_f32 v79, v79
  ds_read_b128 v[48:51], v123 offset:51200
  s_waitcnt lgkmcnt(4)
  v_mfma_f32_32x32x16_bf16 v[32:47], v[184:187], v[52:55], v[32:47]
  v_rcp_f32 v80, v80
  v_rcp_f32 v81, v81
  v_rcp_f32 v82, v82
  ds_read_b128 v[52:55], v123 offset:52224
  s_waitcnt lgkmcnt(4)
  v_mfma_f32_32x32x16_bf16 v[32:47], v[188:191], v[56:59], v[32:47]
  v_rcp_f32 v83, v83
  v_mul_f32 v76, v76, v16
  v_mul_f32 v77, v77, v17
  ds_read_b128 v[56:59], v123 offset:53248
  s_waitcnt lgkmcnt(4)
  v_mfma_f32_32x32x16_bf16 v[32:47], v[192:195], v[60:63], v[32:47]
  v_mul_f32 v78, v78, v18
  v_mul_f32 v79, v79, v19
  v_mul_f32 v80, v80, v20
  ds_read_b128 v[60:63], v123 offset:54272
  s_waitcnt lgkmcnt(4)
  v_mfma_f32_32x32x16_bf16 v[32:47], v[196:199], v[64:67], v[32:47]
  v_mul_f32 v81, v81, v21
  v_mul_f32 v82, v82, v22
  v_mul_f32 v83, v83, v23
  ds_read_b128 v[64:67], v123 offset:55296
  s_waitcnt lgkmcnt(4)
  v_mfma_f32_32x32x16_bf16 v[32:47], v[200:203], v[48:51], v[32:47]
  v_cvt_pk_bf16_f32 v84, v76, v77
  v_cvt_pk_bf16_f32 v85, v78, v79
  v_cvt_pk_bf16_f32 v86, v80, v81
  ds_read_b128 v[48:51], v123 offset:56320
  s_waitcnt lgkmcnt(4)
  v_mfma_f32_32x32x16_bf16 v[32:47], v[204:207], v[52:55], v[32:47]
  v_cvt_pk_bf16_f32 v87, v82, v83
  s_add_u32 s61, s79, 0
  s_cmp_eq_u32 s3, 1
  s_cbranch_scc1 L_stf_74
  buffer_store_dwordx4 v[84:87], v123, s[32:35], s61 offen sc1
  s_branch L_stj_75
L_stf_74:
  buffer_store_dwordx4 v[84:87], v123, s[32:35], s61 offen
L_stj_75:
  ds_read_b128 v[52:55], v123 offset:57344
  s_waitcnt lgkmcnt(4)
  v_mfma_f32_32x32x16_bf16 v[32:47], v[208:211], v[56:59], v[32:47]
  ds_read_b128 v[56:59], v123 offset:58368
  s_waitcnt lgkmcnt(4)
  v_mfma_f32_32x32x16_bf16 v[32:47], v[212:215], v[60:63], v[32:47]
  ds_read_b128 v[60:63], v123 offset:59392
  s_waitcnt lgkmcnt(4)
  v_mfma_f32_32x32x16_bf16 v[32:47], v[216:219], v[64:67], v[32:47]
  ds_read_b128 v[64:67], v123 offset:60416
  s_waitcnt lgkmcnt(4)
  v_mfma_f32_32x32x16_bf16 v[32:47], v[220:223], v[48:51], v[32:47]
  ds_read_b128 v[48:51], v123 offset:61440
  s_waitcnt lgkmcnt(4)
  v_mfma_f32_32x32x16_bf16 v[32:47], v[224:227], v[52:55], v[32:47]
  ds_read_b128 v[52:55], v123 offset:62464
  s_waitcnt lgkmcnt(4)
  v_mfma_f32_32x32x16_bf16 v[32:47], v[228:231], v[56:59], v[32:47]
  ds_read_b128 v[56:59], v123 offset:63488
  s_waitcnt lgkmcnt(4)
  v_mfma_f32_32x32x16_bf16 v[32:47], v[232:235], v[60:63], v[32:47]
  s_waitcnt vmcnt(5)
  s_waitcnt vmcnt(17)
  s_barrier
  v_bfe_u32 v2, v1, 4, 1
  v_bfe_u32 v3, v1, 2, 2
  v_and_b32 v4, 3, v1
  v_lshrrev_b32 v5, 5, v1
  v_lshl_add_u32 v7, v5, 2, v3
  v_lshlrev_b32 v6, 1, v2
  v_lshrrev_b32 v5, 1, v4
  v_add_u32 v6, v6, v5
  v_lshrrev_b32 v5, 1, v3
  v_lshlrev_b32 v5, 2, v5
  v_xor_b32 v6, v6, v5
  v_lshlrev_b32 v6, 4, v6
  v_and_b32 v5, 1, v4
  v_lshl_add_u32 v6, v5, 3, v6
  v_lshl_add_u32 v125, v7, 7, v6
  s_lshl_b32 s54, s87, 11
  v_add_u32 v125, s54, v125
  v_xor_b32 v126, 64, v125
  v_add_u32 v118, 0x20000, v125
  v_add_u32 v119, 0x20000, v126
  ds_read_b128 v[60:63], v123 offset:64512
  s_waitcnt lgkmcnt(4)
  v_mfma_f32_32x32x16_bf16 v[32:47], v[236:239], v[64:67], v[32:47]
  ds_read_b128 v[64:67], v121 offset:0
  s_waitcnt lgkmcnt(4)
  v_mfma_f32_32x32x16_bf16 v[32:47], v[240:243], v[48:51], v[32:47]
  ds_read_b128 v[48:51], v121 offset:1024
  s_waitcnt lgkmcnt(4)
  v_mfma_f32_32x32x16_bf16 v[32:47], v[244:247], v[52:55], v[32:47]
  s_add_u32 m0, s78, 0
  s_add_u32 s62, s77, 65536
  buffer_load_dwordx4 v122, s[44:47], s62 offen lds
  s_waitcnt vmcnt(1)
  s_add_u32 s60, s82, 0
  s_mov_b64 exec, 1
  s_cmp_eq_u32 s3, 1
  s_cbranch_scc1 L_stf_76
  buffer_store_dword v89, v88, s[32:35], s60 offen sc1
  s_branch L_stj_77
L_stf_76:
  buffer_store_dword v89, v88, s[32:35], s60 offen
L_stj_77:
  s_mov_b64 exec, -1
  ds_read_b128 v[52:55], v121 offset:2048
  s_waitcnt lgkmcnt(4)
  v_mfma_f32_32x32x16_bf16 v[32:47], v[248:251], v[56:59], v[32:47]
  ds_read_b128 v[56:59], v121 offset:3072
  s_waitcnt lgkmcnt(4)
  v_mfma_f32_32x32x16_bf16 v[32:47], v[252:255], v[60:63], v[32:47]
  ds_read_b128 v[60:63], v121 offset:4096
  s_waitcnt lgkmcnt(4)
  v_mfma_f32_32x32x16_bf16 v[16:31], v[128:131], v[64:67], 0
  s_add_u32 m0, s78, 8192
  s_add_u32 s62, s77, 81920
  buffer_load_dwordx4 v122, s[44:47], s62 offen lds
  ds_read_b128 v[64:67], v121 offset:5120
  s_waitcnt lgkmcnt(4)
  v_mfma_f32_32x32x16_bf16 v[16:31], v[132:135], v[48:51], v[16:31]
  ds_read_b128 v[48:51], v121 offset:6144
  s_waitcnt lgkmcnt(4)
  v_mfma_f32_32x32x16_bf16 v[16:31], v[136:139], v[52:55], v[16:31]
  ds_read_b64_tr_b16 v[8:9], v118 offset:0
  v_mul_f32 v76, 0xbfb8aa3b, v32
  v_mul_f32 v77, 0xbfb8aa3b, v33
  v_mul_f32 v78, 0xbfb8aa3b, v34
  ds_read_b128 v[52:55], v121 offset:7168
  s_waitcnt lgkmcnt(5)
  v_mfma_f32_32x32x16_bf16 v[16:31], v[140:143], v[56:59], v[16:31]
  s_add_u32 m0, s78, 16384
  s_add_u32 s62, s77, 98304
  buffer_load_dwordx4 v122, s[44:47], s62 offen lds
  ds_read_b64_tr_b16 v[10:11], v118 offset:1024
  v_mul_f32 v79, 0xbfb8aa3b, v35
  v_mul_f32 v80, 0xbfb8aa3b, v36
  v_mul_f32 v81, 0xbfb8aa3b, v37
  ds_read_b128 v[56:59], v121 offset:8192
  s_waitcnt lgkmcnt(6)
  v_mfma_f32_32x32x16_bf16 v[16:31], v[144:147], v[60:63], v[16:31]
  ds_read_b64_tr_b16 v[12:13], v119 offset:0
  v_mul_f32 v82, 0xbfb8aa3b, v38
  v_mul_f32 v83, 0xbfb8aa3b, v39
  v_exp_f32 v76, v76
  ds_read_b128 v[60:63], v121 offset:9216
  s_waitcnt lgkmcnt(7)
  v_mfma_f32_32x32x16_bf16 v[16:31], v[148:151], v[64:67], v[16:31]
  ds_read_b64_tr_b16 v[14:15], v119 offset:1024
  v_exp_f32 v77, v77
  v_exp_f32 v78, v78
  v_exp_f32 v79, v79
  ds_read_b128 v[64:67], v121 offset:10240
  s_waitcnt lgkmcnt(8)
  v_mfma_f32_32x32x16_bf16 v[16:31], v[152:155], v[48:51], v[16:31]
  s_add_u32 m0, s78, 24576
  s_add_u32 s62, s77, 114688
  buffer_load_dwordx4 v122, s[44:47], s62 offen lds
  ds_read_b64_tr_b16 v[68:69], v118 offset:8192
  v_exp_f32 v80, v80
  v_exp_f32 v81, v81
  v_exp_f32 v82, v82
  ds_read_b128 v[48:51], v121 offset:11264
  s_waitcnt lgkmcnt(8)
  v_mfma_f32_32x32x16_bf16 v[16:31], v[156:159], v[52:55], v[16:31]
  ds_read_b64_tr_b16 v[70:71], v118 offset:9216
  v_exp_f32 v83, v83
  v_mul_f32 v32, v32, v40
  v_mul_f32 v33, v33, v41
  ds_read_b128 v[52:55], v121 offset:12288
  s_waitcnt lgkmcnt(8)
  v_mfma_f32_32x32x16_bf16 v[16:31], v[160:163], v[56:59], v[16:31]
  ds_read_b64_tr_b16 v[72:73], v119 offset:8192
  v_mul_f32 v34, v34, v42
  v_mul_f32 v35, v35, v43
  v_mul_f32 v36, v36, v44
  ds_read_b128 v[56:59], v121 offset:13312
  s_waitcnt lgkmcnt(8)
  v_mfma_f32_32x32x16_bf16 v[16:31], v[164:167], v[60:63], v[16:31]
  ds_read_b64_tr_b16 v[74:75], v119 offset:9216
  v_mul_f32 v37, v37, v45
  v_mul_f32 v38, v38, v46
  v_mul_f32 v39, v39, v47
  ds_read_b128 v[60:63], v121 offset:14336
  s_waitcnt lgkmcnt(8)
  v_mfma_f32_32x32x16_bf16 v[16:31], v[168:171], v[64:67], v[16:31]
  ds_read_b64_tr_b16 v[90:91], v118 offset:16384
  v_add_f32 v76, 1.0, v76
  v_add_f32 v77, 1.0, v77
  v_add_f32 v78, 1.0, v78
  ds_read_b128 v[64:67], v121 offset:15360
  s_waitcnt lgkmcnt(8)
  v_mfma_f32_32x32x16_bf16 v[16:31], v[172:175], v[48:51], v[16:31]
  ds_read_b64_tr_b16 v[92:93], v118 offset:17408
  v_add_f32 v79, 1.0, v79
  v_add_f32 v80, 1.0, v80
  v_add_f32 v81, 1.0, v81
  ds_read_b128 v[48:51], v121 offset:16384
  s_waitcnt lgkmcnt(8)
  v_mfma_f32_32x32x16_bf16 v[16:31], v[176:179], v[52:55], v[16:31]
  ds_read_b64_tr_b16 v[94:95], v119 offset:16384
  v_add_f32 v82, 1.0, v82
  v_add_f32 v83, 1.0, v83
  v_rcp_f32 v76, v76
  ds_read_b128 v[52:55], v121 offset:17408
  s_waitcnt lgkmcnt(8)
  v_mfma_f32_32x32x16_bf16 v[16:31], v[180:183], v[56:59], v[16:31]
  ds_read_b64_tr_b16 v[96:97], v119 offset:17408
  v_rcp_f32 v77, v77
  v_rcp_f32 v78, v78
  v_rcp_f32 v79, v79
  ds_read_b128 v[56:59], v121 offset:18432
  s_waitcnt lgkmcnt(8)
  v_mfma_f32_32x32x16_bf16 v[16:31], v[184:187], v[60:63], v[16:31]
  ds_read_b64_tr_b16 v[98:99], v118 offset:24576
  v_rcp_f32 v80, v80
  v_rcp_f32 v81, v81
  v_rcp_f32 v82, v82
  ds_read_b128 v[60:63], v121 offset:19456
  s_waitcnt lgkmcnt(8)
  v_mfma_f32_32x32x16_bf16 v[16:31], v[188:191], v[64:67], v[16:31]
  ds_read_b64_tr_b16 v[100:101], v118 offset:25600
  v_rcp_f32 v83, v83
  v_mul_f32 v76, v76, v32
  v_mul_f32 v77, v77, v33
  ds_read_b128 v[64:67], v121 offset:20480
  s_waitcnt lgkmcnt(8)
  v_mfma_f32_32x32x16_bf16 v[16:31], v[192:195], v[48:51], v[16:31]
  ds_read_b64_tr_b16 v[112:113], v119 offset:24576
  v_mul_f32 v78, v78, v34
  v_mul_f32 v79, v79, v35
  v_mul_f32 v80, v80, v36
  ds_read_b128 v[48:51], v121 offset:21504
  s_waitcnt lgkmcnt(8)
  v_mfma_f32_32x32x16_bf16 v[16:31], v[196:199], v[52:55], v[16:31]
  ds_read_b64_tr_b16 v[114:115], v119 offset:25600
  v_mul_f32 v81, v81, v37
  v_mul_f32 v82, v82, v38
  v_mul_f32 v83, v83, v39
  ds_read_b128 v[52:55], v121 offset:22528
  s_waitcnt lgkmcnt(8)
  v_mfma_f32_32x32x16_bf16 v[16:31], v[200:203], v[56:59], v[16:31]
  v_cvt_pk_bf16_f32 v84, v76, v77
  v_cvt_pk_bf16_f32 v85, v78, v79
  v_cvt_pk_bf16_f32 v86, v80, v81
  ds_read_b128 v[56:59], v121 offset:23552
  s_waitcnt lgkmcnt(7)
  v_mfma_f32_32x32x16_bf16 v[16:31], v[204:207], v[60:63], v[16:31]
  v_cvt_pk_bf16_f32 v87, v82, v83
  s_add_u32 s61, s79, 114688
  s_cmp_eq_u32 s3, 1
  s_cbranch_scc1 L_stf_78
  buffer_store_dwordx4 v[84:87], v123, s[32:35], s61 offen sc1
  s_branch L_stj_79
L_stf_78:
  buffer_store_dwordx4 v[84:87], v123, s[32:35], s61 offen
L_stj_79:
  ds_read_b128 v[60:63], v121 offset:24576
  s_waitcnt lgkmcnt(6)
  v_mfma_f32_32x32x16_bf16 v[16:31], v[208:211], v[64:67], v[16:31]
  ds_read_b128 v[64:67], v121 offset:25600
  s_waitcnt lgkmcnt(5)
  v_mfma_f32_32x32x16_bf16 v[16:31], v[212:215], v[48:51], v[16:31]
  ds_read_b128 v[48:51], v121 offset:26624
  s_waitcnt lgkmcnt(4)
  v_mfma_f32_32x32x16_bf16 v[16:31], v[216:219], v[52:55], v[16:31]
  ds_read_b128 v[52:55], v121 offset:27648
  s_waitcnt lgkmcnt(4)
  v_mfma_f32_32x32x16_bf16 v[16:31], v[220:223], v[56:59], v[16:31]
  ds_read_b128 v[56:59], v121 offset:28672
  s_waitcnt lgkmcnt(4)
  v_mfma_f32_32x32x16_bf16 v[16:31], v[224:227], v[60:63], v[16:31]
  ds_read_b128 v[60:63], v121 offset:29696
  s_waitcnt lgkmcnt(4)
  v_mfma_f32_32x32x16_bf16 v[16:31], v[228:231], v[64:67], v[16:31]
  ds_read_b128 v[64:67], v121 offset:30720
  s_waitcnt lgkmcnt(4)
  v_mfma_f32_32x32x16_bf16 v[16:31], v[232:235], v[48:51], v[16:31]
  s_waitcnt vmcnt(7)
  s_waitcnt vmcnt(1)
  s_barrier
  ds_read_b128 v[48:51], v121 offset:31744
  s_waitcnt lgkmcnt(4)
  v_mfma_f32_32x32x16_bf16 v[16:31], v[236:239], v[52:55], v[16:31]
  s_add_u32 m0, s78, 32768
  s_add_u32 s62, s77, 131072
  buffer_load_dwordx4 v122, s[44:47], s62 offen lds
  ds_read_b128 v[52:55], v121 offset:32768
  s_waitcnt lgkmcnt(4)
  v_mfma_f32_32x32x16_bf16 v[16:31], v[240:243], v[56:59], v[16:31]
  ds_read_b128 v[56:59], v121 offset:33792
  s_waitcnt lgkmcnt(4)
  v_mfma_f32_32x32x16_bf16 v[16:31], v[244:247], v[60:63], v[16:31]
  s_add_u32 m0, s78, 40960
  s_add_u32 s62, s77, 147456
  buffer_load_dwordx4 v122, s[44:47], s62 offen lds
  s_waitcnt vmcnt(2)
  s_add_u32 s60, s82, 512
  s_mov_b64 exec, 1
  s_cmp_eq_u32 s3, 1
  s_cbranch_scc1 L_stf_80
  buffer_store_dword v89, v88, s[32:35], s60 offen sc1
  s_branch L_stj_81
L_stf_80:
  buffer_store_dword v89, v88, s[32:35], s60 offen
L_stj_81:
  s_mov_b64 exec, -1
  ds_read_b128 v[60:63], v121 offset:34816
  s_waitcnt lgkmcnt(4)
  v_mfma_f32_32x32x16_bf16 v[16:31], v[248:251], v[64:67], v[16:31]
  ds_read_b128 v[64:67], v121 offset:35840
  s_waitcnt lgkmcnt(4)
  v_mfma_f32_32x32x16_bf16 v[16:31], v[252:255], v[48:51], v[16:31]
  s_add_u32 m0, s78, 49152
  s_add_u32 s62, s77, 163840
  buffer_load_dwordx4 v122, s[44:47], s62 offen lds
  ds_read_b128 v[48:51], v121 offset:36864
  s_waitcnt lgkmcnt(4)
  v_mfma_f32_32x32x16_bf16 v[32:47], v[128:131], v[52:55], 0
  ds_read_b128 v[52:55], v121 offset:37888
  s_waitcnt lgkmcnt(4)
  v_mfma_f32_32x32x16_bf16 v[32:47], v[132:135], v[56:59], v[32:47]
  s_add_u32 m0, s78, 57344
  s_add_u32 s62, s77, 180224
  buffer_load_dwordx4 v122, s[44:47], s62 offen lds
  ds_read_b128 v[56:59], v121 offset:38912
  s_waitcnt lgkmcnt(4)
  v_mfma_f32_32x32x16_bf16 v[32:47], v[136:139], v[60:63], v[32:47]
  v_mul_f32 v76, 0xbfb8aa3b, v16
  v_mul_f32 v77, 0xbfb8aa3b, v17
  v_mul_f32 v78, 0xbfb8aa3b, v18
  ds_read_b128 v[60:63], v121 offset:39936
  s_waitcnt lgkmcnt(4)
  v_mfma_f32_32x32x16_bf16 v[32:47], v[140:143], v[64:67], v[32:47]
  s_add_u32 m0, s78, 131072
  s_add_u32 s62, s77, 262144
  buffer_load_dwordx4 v122, s[44:47], s62 offen lds
  ds_read_b64_tr_b16 v[128:129], v125 offset:0
  ds_read_b64_tr_b16 v[130:131], v125 offset:1024
  v_mul_f32 v79, 0xbfb8aa3b, v19
  v_mul_f32 v80, 0xbfb8aa3b, v20
  v_mul_f32 v81, 0xbfb8aa3b, v21
  ds_read_b128 v[64:67], v121 offset:40960
  s_waitcnt lgkmcnt(6)
  v_mfma_f32_32x32x16_bf16 v[32:47], v[144:147], v[48:51], v[32:47]
  ds_read_b64_tr_b16 v[132:133], v126 offset:0
  ds_read_b64_tr_b16 v[134:135], v126 offset:1024
  v_mul_f32 v82, 0xbfb8aa3b, v22
  v_mul_f32 v83, 0xbfb8aa3b, v23
  v_exp_f32 v76, v76
  ds_read_b128 v[48:51], v121 offset:41984
  s_waitcnt lgkmcnt(8)
  v_mfma_f32_32x32x16_bf16 v[32:47], v[148:151], v[52:55], v[32:47]
  s_add_u32 m0, s78, 139264
  s_add_u32 s62, s77, 278528
  buffer_load_dwordx4 v122, s[44:47], s62 offen lds
  ds_read_b64_tr_b16 v[136:137], v125 offset:8192
  ds_read_b64_tr_b16 v[138:139], v125 offset:9216
  v_exp_f32 v77, v77
  v_exp_f32 v78, v78
  v_exp_f32 v79, v79
  ds_read_b128 v[52:55], v121 offset:43008
  s_waitcnt lgkmcnt(10)
  v_mfma_f32_32x32x16_bf16 v[32:47], v[152:155], v[56:59], v[32:47]
  ds_read_b64_tr_b16 v[140:141], v126 offset:8192
  ds_read_b64_tr_b16 v[142:143], v126 offset:9216
  v_exp_f32 v80, v80
  v_exp_f32 v81, v81
  v_exp_f32 v82, v82
  ds_read_b128 v[56:59], v121 offset:44032
  s_waitcnt lgkmcnt(12)
  v_mfma_f32_32x32x16_bf16 v[32:47], v[156:159], v[60:63], v[32:47]
  s_add_u32 m0, s78, 147456
  s_add_u32 s62, s77, 294912
  buffer_load_dwordx4 v122, s[44:47], s62 offen lds
  ds_read_b64_tr_b16 v[144:145], v125 offset:16384
  ds_read_b64_tr_b16 v[146:147], v125 offset:17408
  v_exp_f32 v83, v83
  v_mul_f32 v16, v16, v24
  v_mul_f32 v17, v17, v25
  s_waitcnt vmcnt(6)
  s_barrier
  ds_read_b128 v[60:63], v121 offset:45056
  s_waitcnt lgkmcnt(12)
  v_mfma_f32_32x32x16_bf16 v[32:47], v[160:163], v[64:67], v[32:47]
  ds_read_b64_tr_b16 v[148:149], v126 offset:16384
  ds_read_b64_tr_b16 v[150:151], v126 offset:17408
  v_mul_f32 v18, v18, v26
  v_mul_f32 v19, v19, v27
  v_mul_f32 v20, v20, v28
  ds_read_b128 v[64:67], v121 offset:46080
  s_waitcnt lgkmcnt(12)
  v_mfma_f32_32x32x16_bf16 v[32:47], v[164:167], v[48:51], v[32:47]
  s_add_u32 m0, s78, 155648
  s_add_u32 s62, s77, 311296
  buffer_load_dwordx4 v122, s[44:47], s62 offen lds
  ds_read_b64_tr_b16 v[152:153], v125 offset:24576
  ds_read_b64_tr_b16 v[154:155], v125 offset:25600
  v_mul_f32 v21, v21, v29
  v_mul_f32 v22, v22, v30
  v_mul_f32 v23, v23, v31
  ds_read_b128 v[48:51], v121 offset:47104
  s_waitcnt lgkmcnt(12)
  v_mfma_f32_32x32x16_bf16 v[32:47], v[168:171], v[52:55], v[32:47]
  ds_read_b64_tr_b16 v[156:157], v126 offset:24576
  ds_read_b64_tr_b16 v[158:159], v126 offset:25600
  v_add_f32 v76, 1.0, v76
  v_add_f32 v77, 1.0, v77
  v_add_f32 v78, 1.0, v78
  ds_read_b128 v[52:55], v121 offset:48128
  s_waitcnt lgkmcnt(12)
  v_mfma_f32_32x32x16_bf16 v[32:47], v[172:175], v[56:59], v[32:47]
  s_add_u32 m0, s78, 65536
  s_add_u32 s62, s77, 196608
  buffer_load_dwordx4 v122, s[44:47], s62 offen lds
  ds_read_b64_tr_b16 v[160:161], v125 offset:32768
  ds_read_b64_tr_b16 v[162:163], v125 offset:33792
  v_add_f32 v79, 1.0, v79
  v_add_f32 v80, 1.0, v80
  v_add_f32 v81, 1.0, v81
  ds_read_b128 v[56:59], v121 offset:49152
  s_waitcnt lgkmcnt(12)
  v_mfma_f32_32x32x16_bf16 v[32:47], v[176:179], v[60:63], v[32:47]
  ds_read_b64_tr_b16 v[164:165], v126 offset:32768
  ds_read_b64_tr_b16 v[166:167], v126 offset:33792
  v_add_f32 v82, 1.0, v82
  v_add_f32 v83, 1.0, v83
  v_rcp_f32 v76, v76
  ds_read_b128 v[60:63], v121 offset:50176
  s_waitcnt lgkmcnt(12)
  v_mfma_f32_32x32x16_bf16 v[32:47], v[180:183], v[64:67], v[32:47]
  s_add_u32 m0, s78, 73728
  s_add_u32 s62, s77, 212992
  buffer_load_dwordx4 v122, s[44:47], s62 offen lds
  ds_read_b64_tr_b16 v[168:169], v125 offset:40960
  ds_read_b64_tr_b16 v[170:171], v125 offset:41984
  v_rcp_f32 v77, v77
  v_rcp_f32 v78, v78
  v_rcp_f32 v79, v79
  ds_read_b128 v[64:67], v121 offset:51200
  s_waitcnt lgkmcnt(12)
  v_mfma_f32_32x32x16_bf16 v[32:47], v[184:187], v[48:51], v[32:47]
  ds_read_b64_tr_b16 v[172:173], v126 offset:40960
  ds_read_b64_tr_b16 v[174:175], v126 offset:41984
  v_rcp_f32 v80, v80
  v_rcp_f32 v81, v81
  v_rcp_f32 v82, v82
  ds_read_b128 v[48:51], v121 offset:52224
  s_waitcnt lgkmcnt(12)
  v_mfma_f32_32x32x16_bf16 v[32:47], v[188:191], v[52:55], v[32:47]
  s_add_u32 m0, s78, 81920
  s_add_u32 s62, s77, 229376
  buffer_load_dwordx4 v122, s[44:47], s62 offen lds
  v_rcp_f32 v83, v83
  v_mul_f32 v76, v76, v16
  v_mul_f32 v77, v77, v17
  ds_read_b128 v[52:55], v121 offset:53248
  s_waitcnt lgkmcnt(10)
  v_mfma_f32_32x32x16_bf16 v[32:47], v[192:195], v[56:59], v[32:47]
  v_mul_f32 v78, v78, v18
  v_mul_f32 v79, v79, v19
  v_mul_f32 v80, v80, v20
  ds_read_b128 v[56:59], v121 offset:54272
  s_waitcnt lgkmcnt(8)
  v_mfma_f32_32x32x16_bf16 v[32:47], v[196:199], v[60:63], v[32:47]
  s_add_u32 m0, s78, 90112
  s_add_u32 s62, s77, 245760
  buffer_load_dwordx4 v122, s[44:47], s62 offen lds
  v_mul_f32 v81, v81, v21
  v_mul_f32 v82, v82, v22
  v_mul_f32 v83, v83, v23
  ds_read_b128 v[60:63], v121 offset:55296
  s_waitcnt lgkmcnt(6)
  v_mfma_f32_32x32x16_bf16 v[32:47], v[200:203], v[64:67], v[32:47]
  v_cvt_pk_bf16_f32 v84, v76, v77
  v_cvt_pk_bf16_f32 v85, v78, v79
  v_cvt_pk_bf16_f32 v86, v80, v81
  ds_read_b128 v[64:67], v121 offset:56320
  s_waitcnt lgkmcnt(4)
  v_mfma_f32_32x32x16_bf16 v[32:47], v[204:207], v[48:51], v[32:47]
  v_cvt_pk_bf16_f32 v87, v82, v83
  s_add_u32 s61, s79, 229376
  s_cmp_eq_u32 s3, 1
  s_cbranch_scc1 L_stf_82
  buffer_store_dwordx4 v[84:87], v123, s[32:35], s61 offen sc1
  s_branch L_stj_83
L_stf_82:
  buffer_store_dwordx4 v[84:87], v123, s[32:35], s61 offen
L_stj_83:
  ds_read_b128 v[48:51], v121 offset:57344
  s_waitcnt lgkmcnt(4)
  v_mfma_f32_32x32x16_bf16 v[32:47], v[208:211], v[52:55], v[32:47]
  ds_read_b128 v[52:55], v121 offset:58368
  s_waitcnt lgkmcnt(4)
  v_mfma_f32_32x32x16_bf16 v[32:47], v[212:215], v[56:59], v[32:47]
  ds_read_b128 v[56:59], v121 offset:59392
  s_waitcnt lgkmcnt(4)
  v_mfma_f32_32x32x16_bf16 v[32:47], v[216:219], v[60:63], v[32:47]
  ds_read_b128 v[60:63], v121 offset:60416
  s_waitcnt lgkmcnt(4)
  v_mfma_f32_32x32x16_bf16 v[32:47], v[220:223], v[64:67], v[32:47]
  ds_read_b128 v[64:67], v121 offset:61440
  s_waitcnt lgkmcnt(4)
  v_mfma_f32_32x32x16_bf16 v[32:47], v[224:227], v[48:51], v[32:47]
  ds_read_b128 v[48:51], v121 offset:62464
  s_waitcnt lgkmcnt(4)
  v_mfma_f32_32x32x16_bf16 v[32:47], v[228:231], v[52:55], v[32:47]
  ds_read_b128 v[52:55], v121 offset:63488
  s_waitcnt lgkmcnt(4)
  v_mfma_f32_32x32x16_bf16 v[32:47], v[232:235], v[56:59], v[32:47]
  ds_read_b128 v[56:59], v121 offset:64512
  s_waitcnt lgkmcnt(4)
  v_mfma_f32_32x32x16_bf16 v[32:47], v[236:239], v[60:63], v[32:47]
  s_waitcnt lgkmcnt(3)
  v_mfma_f32_32x32x16_bf16 v[32:47], v[240:243], v[64:67], v[32:47]
  s_waitcnt lgkmcnt(2)
  v_mfma_f32_32x32x16_bf16 v[32:47], v[244:247], v[48:51], v[32:47]
  s_waitcnt vmcnt(0)
  s_add_u32 s60, s82, 1024
  s_mov_b64 exec, 1
  s_cmp_eq_u32 s3, 1
  s_cbranch_scc1 L_stf_84
  buffer_store_dword v89, v88, s[32:35], s60 offen sc1
  s_branch L_stj_85
L_stf_84:
  buffer_store_dword v89, v88, s[32:35], s60 offen
L_stj_85:
  s_mov_b64 exec, -1
  s_waitcnt lgkmcnt(1)
  v_mfma_f32_32x32x16_bf16 v[32:47], v[248:251], v[52:55], v[32:47]
  s_waitcnt lgkmcnt(0)
  v_mfma_f32_32x32x16_bf16 v[32:47], v[252:255], v[56:59], v[32:47]
  s_waitcnt lgkmcnt(0)
  s_nop 10
  v_mul_f32 v76, 0xbfb8aa3b, v32
  v_mul_f32 v77, 0xbfb8aa3b, v33
  v_mul_f32 v78, 0xbfb8aa3b, v34
  v_mul_f32 v79, 0xbfb8aa3b, v35
  v_mul_f32 v80, 0xbfb8aa3b, v36
  v_mul_f32 v81, 0xbfb8aa3b, v37
  v_mul_f32 v82, 0xbfb8aa3b, v38
  v_mul_f32 v83, 0xbfb8aa3b, v39
  v_exp_f32 v76, v76
  v_exp_f32 v77, v77
  v_exp_f32 v78, v78
  v_exp_f32 v79, v79
  v_exp_f32 v80, v80
  v_exp_f32 v81, v81
  v_exp_f32 v82, v82
  v_exp_f32 v83, v83
  v_mul_f32 v32, v32, v40
  v_mul_f32 v33, v33, v41
  v_mul_f32 v34, v34, v42
  v_mul_f32 v35, v35, v43
  v_mul_f32 v36, v36, v44
  v_mul_f32 v37, v37, v45
  v_mul_f32 v38, v38, v46
  v_mul_f32 v39, v39, v47
  v_add_f32 v76, 1.0, v76
  v_add_f32 v77, 1.0, v77
  v_add_f32 v78, 1.0, v78
  v_add_f32 v79, 1.0, v79
  v_add_f32 v80, 1.0, v80
  v_add_f32 v81, 1.0, v81
  v_add_f32 v82, 1.0, v82
  v_add_f32 v83, 1.0, v83
  v_rcp_f32 v76, v76
  v_rcp_f32 v77, v77
  v_rcp_f32 v78, v78
  v_rcp_f32 v79, v79
  v_rcp_f32 v80, v80
  v_rcp_f32 v81, v81
  v_rcp_f32 v82, v82
  v_rcp_f32 v83, v83
  v_mul_f32 v76, v76, v32
  v_mul_f32 v77, v77, v33
  v_mul_f32 v78, v78, v34
  v_mul_f32 v79, v79, v35
  v_mul_f32 v80, v80, v36
  v_mul_f32 v81, v81, v37
  v_mul_f32 v82, v82, v38
  v_mul_f32 v83, v83, v39
  v_cvt_pk_bf16_f32 v84, v76, v77
  v_cvt_pk_bf16_f32 v85, v78, v79
  v_cvt_pk_bf16_f32 v86, v80, v81
  v_cvt_pk_bf16_f32 v87, v82, v83
  s_add_u32 s61, s79, 344064
  s_cmp_eq_u32 s3, 1
  s_cbranch_scc1 L_stf_86
  buffer_store_dwordx4 v[84:87], v123, s[32:35], s61 offen sc1
  s_branch L_stj_87
L_stf_86:
  buffer_store_dwordx4 v[84:87], v123, s[32:35], s61 offen
L_stj_87:
  s_waitcnt vmcnt(0)
  s_add_u32 s60, s82, 1536
  s_mov_b64 exec, 1
  s_cmp_eq_u32 s3, 1
  s_cbranch_scc1 L_stf_88
  buffer_store_dword v89, v88, s[32:35], s60 offen sc1
  s_branch L_stj_89
L_stf_88:
  buffer_store_dword v89, v88, s[32:35], s60 offen
L_stj_89:
  s_mov_b64 exec, -1
  s_barrier
  s_branch L_Ej_70
L_noE_69:
  s_add_u32 m0, s78, 131072
  s_add_u32 s62, s77, 0
  buffer_load_dwordx4 v122, s[44:47], s62 offen lds
  s_add_u32 m0, s78, 139264
  s_add_u32 s62, s77, 16384
  buffer_load_dwordx4 v122, s[44:47], s62 offen lds
  s_add_u32 m0, s78, 147456
  s_add_u32 s62, s77, 32768
  buffer_load_dwordx4 v122, s[44:47], s62 offen lds
  s_add_u32 m0, s78, 155648
  s_add_u32 s62, s77, 49152
  buffer_load_dwordx4 v122, s[44:47], s62 offen lds
  s_add_u32 m0, s78, 0
  s_add_u32 s62, s77, 65536
  buffer_load_dwordx4 v122, s[44:47], s62 offen lds
  s_add_u32 m0, s78, 8192
  s_add_u32 s62, s77, 81920
  buffer_load_dwordx4 v122, s[44:47], s62 offen lds
  s_add_u32 m0, s78, 16384
  s_add_u32 s62, s77, 98304
  buffer_load_dwordx4 v122, s[44:47], s62 offen lds
  s_add_u32 m0, s78, 24576
  s_add_u32 s62, s77, 114688
  buffer_load_dwordx4 v122, s[44:47], s62 offen lds
  s_add_u32 m0, s78, 32768
  s_add_u32 s62, s77, 131072
  buffer_load_dwordx4 v122, s[44:47], s62 offen lds
  s_add_u32 m0, s78, 40960
  s_add_u32 s62, s77, 147456
  buffer_load_dwordx4 v122, s[44:47], s62 offen lds
  s_add_u32 m0, s78, 49152
  s_add_u32 s62, s77, 163840
  buffer_load_dwordx4 v122, s[44:47], s62 offen lds
  s_add_u32 m0, s78, 57344
  s_add_u32 s62, s77, 180224
  buffer_load_dwordx4 v122, s[44:47], s62 offen lds
  s_add_u32 m0, s78, 65536
  s_add_u32 s62, s77, 196608
  buffer_load_dwordx4 v122, s[44:47], s62 offen lds
  s_add_u32 m0, s78, 73728
  s_add_u32 s62, s77, 212992
  buffer_load_dwordx4 v122, s[44:47], s62 offen lds
  s_add_u32 m0, s78, 81920
  s_add_u32 s62, s77, 229376
  buffer_load_dwordx4 v122, s[44:47], s62 offen lds
  s_add_u32 m0, s78, 90112
  s_add_u32 s62, s77, 245760
  buffer_load_dwordx4 v122, s[44:47], s62 offen lds
  v_bfe_u32 v2, v1, 4, 1
  v_bfe_u32 v3, v1, 2, 2
  v_and_b32 v4, 3, v1
  v_lshrrev_b32 v5, 5, v1
  v_lshl_add_u32 v7, v5, 2, v3
  v_lshlrev_b32 v6, 1, v2
  v_lshrrev_b32 v5, 1, v4
  v_add_u32 v6, v6, v5
  v_lshrrev_b32 v5, 1, v3
  v_lshlrev_b32 v5, 2, v5
  v_xor_b32 v6, v6, v5
  v_lshlrev_b32 v6, 4, v6
  v_and_b32 v5, 1, v4
  v_lshl_add_u32 v6, v5, 3, v6
  v_lshl_add_u32 v125, v7, 7, v6
  s_lshl_b32 s54, s87, 11
  v_add_u32 v125, s54, v125
  v_xor_b32 v126, 64, v125
  v_add_u32 v118, 0x20000, v125
  v_add_u32 v119, 0x20000, v126
  s_waitcnt vmcnt(0)
  s_barrier
  ds_read_b64_tr_b16 v[8:9], v118 offset:0
  ds_read_b64_tr_b16 v[10:11], v118 offset:1024
  ds_read_b64_tr_b16 v[12:13], v119 offset:0
  ds_read_b64_tr_b16 v[14:15], v119 offset:1024
  ds_read_b64_tr_b16 v[68:69], v118 offset:8192
  ds_read_b64_tr_b16 v[70:71], v118 offset:9216
  ds_read_b64_tr_b16 v[72:73], v119 offset:8192
  ds_read_b64_tr_b16 v[74:75], v119 offset:9216
  ds_read_b64_tr_b16 v[90:91], v118 offset:16384
  ds_read_b64_tr_b16 v[92:93], v118 offset:17408
  ds_read_b64_tr_b16 v[94:95], v119 offset:16384
  ds_read_b64_tr_b16 v[96:97], v119 offset:17408
  s_waitcnt lgkmcnt(4)
  ds_read_b64_tr_b16 v[98:99], v118 offset:24576
  ds_read_b64_tr_b16 v[100:101], v118 offset:25600
  ds_read_b64_tr_b16 v[112:113], v119 offset:24576
  ds_read_b64_tr_b16 v[114:115], v119 offset:25600
  ds_read_b64_tr_b16 v[128:129], v125 offset:0
  ds_read_b64_tr_b16 v[130:131], v125 offset:1024
  ds_read_b64_tr_b16 v[132:133], v126 offset:0
  ds_read_b64_tr_b16 v[134:135], v126 offset:1024
  ds_read_b64_tr_b16 v[136:137], v125 offset:8192
  ds_read_b64_tr_b16 v[138:139], v125 offset:9216
  ds_read_b64_tr_b16 v[140:141], v126 offset:8192
  ds_read_b64_tr_b16 v[142:143], v126 offset:9216
  s_waitcnt lgkmcnt(4)
  ds_read_b64_tr_b16 v[144:145], v125 offset:16384
  ds_read_b64_tr_b16 v[146:147], v125 offset:17408
  ds_read_b64_tr_b16 v[148:149], v126 offset:16384
  ds_read_b64_tr_b16 v[150:151], v126 offset:17408
  ds_read_b64_tr_b16 v[152:153], v125 offset:24576
  ds_read_b64_tr_b16 v[154:155], v125 offset:25600
  ds_read_b64_tr_b16 v[156:157], v126 offset:24576
  ds_read_b64_tr_b16 v[158:159], v126 offset:25600
  ds_read_b64_tr_b16 v[160:161], v125 offset:32768
  ds_read_b64_tr_b16 v[162:163], v125 offset:33792
  ds_read_b64_tr_b16 v[164:165], v126 offset:32768
  ds_read_b64_tr_b16 v[166:167], v126 offset:33792
  s_waitcnt lgkmcnt(4)
  ds_read_b64_tr_b16 v[168:169], v125 offset:40960
  ds_read_b64_tr_b16 v[170:171], v125 offset:41984
  ds_read_b64_tr_b16 v[172:173], v126 offset:40960
  ds_read_b64_tr_b16 v[174:175], v126 offset:41984
  s_waitcnt lgkmcnt(0)
  s_barrier
  s_add_u32 m0, s78, 131072
  s_add_u32 s62, s77, 262144
  buffer_load_dwordx4 v122, s[44:47], s62 offen lds
  s_add_u32 m0, s78, 139264
  s_add_u32 s62, s77, 278528
  buffer_load_dwordx4 v122, s[44:47], s62 offen lds
  s_add_u32 m0, s78, 147456
  s_add_u32 s62, s77, 294912
  buffer_load_dwordx4 v122, s[44:47], s62 offen lds
  s_add_u32 m0, s78, 155648
  s_add_u32 s62, s77, 311296
  buffer_load_dwordx4 v122, s[44:47], s62 offen lds
  s_waitcnt vmcnt(0)
  s_barrier
L_Ej_70:
  v_add_u32 v120, 0x10000, v125
  v_add_u32 v121, 0x10000, v126
  s_lshl_b32 s54, s48, 2
  s_add_u32 s54, s54, s75
  s_lshl_b32 s56, s54, 9
  s_mul_i32 s54, s54, 112
  s_mul_i32 s55, s87, 28
  s_add_u32 s54, s54, s55
  s_lshl_b32 s54, s54, 10
  s_add_u32 s80, s54, 5242880
  s_lshl_b32 s55, s55, 2
  s_add_u32 s56, s56, s55
  s_add_u32 s56, s56, 655360
  v_lshlrev_b32 v124, 4, v1
  v_lshlrev_b32 v2, 2, v1
  v_add_u32 v2, s56, v2
  s_mov_b32 exec_lo, 0xfffffff
  s_mov_b32 exec_hi, 0
  s_mov_b32 s86, 400000
L_poll_90:
  buffer_load_dword v4, v2, s[32:35], 0 offen sc1
  s_waitcnt vmcnt(0)
  v_cmp_ne_u32 vcc, s53, v4
  s_sub_u32 s86, s86, 1
  s_cmp_eq_u32 s86, 0
  s_cbranch_scc1 L_pollout_91
  s_cbranch_vccnz L_poll_90
L_pollout_91:
  s_mov_b64 exec, -1
  buffer_load_dwordx4 v[208:211], v124, s[32:35], s80 offen sc1
  s_add_u32 s80, s80, 1024
  buffer_load_dwordx4 v[212:215], v124, s[32:35], s80 offen sc1
  s_add_u32 s80, s80, 1024
  buffer_load_dwordx4 v[216:219], v124, s[32:35], s80 offen sc1
  s_add_u32 s80, s80, 1024
  buffer_load_dwordx4 v[220:223], v124, s[32:35], s80 offen sc1
  s_add_u32 s80, s80, 1024
  buffer_load_dwordx4 v[224:227], v124, s[32:35], s80 offen sc1
  s_add_u32 s80, s80, 1024
  buffer_load_dwordx4 v[228:231], v124, s[32:35], s80 offen sc1
  s_add_u32 s80, s80, 1024
  buffer_load_dwordx4 v[232:235], v124, s[32:35], s80 offen sc1
  s_add_u32 s80, s80, 1024
  s_mul_i32 s54, s90, 16384
  s_add_u32 s54, s54, 524288
  s_lshl_b32 s55, s74, 2
  s_add_u32 s54, s54, s55
  v_lshrrev_b32 v6, 5, v1
  v_lshlrev_b32 v6, 4, v6
  v_add_u32 v6, s54, v6
  s_mov_b32 s54, 10240
  buffer_load_dwordx4 v[80:83], v6, s[32:35], s54 offen sc1
  buffer_load_dwordx4 v[84:87], v6, s[32:35], s54 offen offset:32 sc1
  s_waitcnt vmcnt(8)
  v_mfma_f32_32x32x16_bf16 v[16:31], v[8:11], v[208:211], 0
  v_mfma_f32_32x32x16_bf16 v[32:47], v[12:15], v[208:211], 0
  buffer_load_dwordx4 v[236:239], v124, s[32:35], s80 offen sc1
  s_add_u32 s80, s80, 1024
  s_add_u32 m0, s78, 0
  s_add_u32 s62, s77, 327680
  buffer_load_dwordx4 v122, s[44:47], s62 offen lds
  s_waitcnt vmcnt(9)
  v_mfma_f32_32x32x16_bf16 v[16:31], v[68:71], v[212:215], v[16:31]
  v_mfma_f32_32x32x16_bf16 v[32:47], v[72:75], v[212:215], v[32:47]
  buffer_load_dwordx4 v[208:211], v124, s[32:35], s80 offen sc1
  s_add_u32 s80, s80, 1024
  s_add_u32 m0, s78, 8192
  s_add_u32 s62, s77, 344064
  buffer_load_dwordx4 v122, s[44:47], s62 offen lds
  s_waitcnt vmcnt(10)
  v_mfma_f32_32x32x16_bf16 v[16:31], v[90:93], v[216:219], v[16:31]
  v_mfma_f32_32x32x16_bf16 v[32:47], v[94:97], v[216:219], v[32:47]
  buffer_load_dwordx4 v[212:215], v124, s[32:35], s80 offen sc1
  s_add_u32 s80, s80, 1024
  s_add_u32 m0, s78, 16384
  s_add_u32 s62, s77, 360448
  buffer_load_dwordx4 v122, s[44:47], s62 offen lds
  s_waitcnt vmcnt(11)
  v_mfma_f32_32x32x16_bf16 v[16:31], v[98:101], v[220:223], v[16:31]
  v_mfma_f32_32x32x16_bf16 v[32:47], v[112:115], v[220:223], v[32:47]
  buffer_load_dwordx4 v[216:219], v124, s[32:35], s80 offen sc1
  s_add_u32 s80, s80, 1024
  s_add_u32 m0, s78, 24576
  s_add_u32 s62, s77, 376832
  buffer_load_dwordx4 v122, s[44:47], s62 offen lds
  s_waitcnt vmcnt(12)
  v_mfma_f32_32x32x16_bf16 v[16:31], v[128:131], v[224:227], v[16:31]
  v_mfma_f32_32x32x16_bf16 v[32:47], v[132:135], v[224:227], v[32:47]
  buffer_load_dwordx4 v[220:223], v124, s[32:35], s80 offen sc1
  s_add_u32 s80, s80, 1024
  s_add_u32 m0, s78, 32768
  s_add_u32 s62, s77, 393216
  buffer_load_dwordx4 v122, s[44:47], s62 offen lds
  s_waitcnt vmcnt(13)
  v_mfma_f32_32x32x16_bf16 v[16:31], v[136:139], v[228:231], v[16:31]
  v_mfma_f32_32x32x16_bf16 v[32:47], v[140:143], v[228:231], v[32:47]
  buffer_load_dwordx4 v[224:227], v124, s[32:35], s80 offen sc1
  s_add_u32 s80, s80, 1024
  s_add_u32 m0, s78, 40960
  s_add_u32 s62, s77, 409600
  buffer_load_dwordx4 v122, s[44:47], s62 offen lds
  s_waitcnt vmcnt(14)
  v_mfma_f32_32x32x16_bf16 v[16:31], v[144:147], v[232:235], v[16:31]
  v_mfma_f32_32x32x16_bf16 v[32:47], v[148:151], v[232:235], v[32:47]
  buffer_load_dwordx4 v[228:231], v124, s[32:35], s80 offen sc1
  s_add_u32 s80, s80, 1024
  s_add_u32 m0, s78, 98304
  s_add_u32 s62, s77, 425984
  buffer_load_dwordx4 v122, s[44:47], s62 offen lds
  s_waitcnt vmcnt(13)
  v_mfma_f32_32x32x16_bf16 v[16:31], v[152:155], v[236:239], v[16:31]
  v_mfma_f32_32x32x16_bf16 v[32:47], v[156:159], v[236:239], v[32:47]
  buffer_load_dwordx4 v[232:235], v124, s[32:35], s80 offen sc1
  s_add_u32 s80, s80, 1024
  s_add_u32 m0, s78, 106496
  s_add_u32 s62, s77, 442368
  buffer_load_dwordx4 v122, s[44:47], s62 offen lds
  ds_read_b64_tr_b16 v[56:57], v125 offset:49152
  ds_read_b64_tr_b16 v[58:59], v125 offset:50176
  ds_read_b64_tr_b16 v[60:61], v126 offset:49152
  ds_read_b64_tr_b16 v[62:63], v126 offset:50176
  s_waitcnt vmcnt(13)
  v_mfma_f32_32x32x16_bf16 v[16:31], v[160:163], v[208:211], v[16:31]
  v_mfma_f32_32x32x16_bf16 v[32:47], v[164:167], v[208:211], v[32:47]
  buffer_load_dwordx4 v[236:239], v124, s[32:35], s80 offen sc1
  s_add_u32 s80, s80, 1024
  ds_read_b64_tr_b16 v[64:65], v125 offset:57344
  ds_read_b64_tr_b16 v[66:67], v125 offset:58368
  ds_read_b64_tr_b16 v[68:69], v126 offset:57344
  ds_read_b64_tr_b16 v[70:71], v126 offset:58368
  s_waitcnt vmcnt(12)
  v_mfma_f32_32x32x16_bf16 v[16:31], v[168:171], v[212:215], v[16:31]
  v_mfma_f32_32x32x16_bf16 v[32:47], v[172:175], v[212:215], v[32:47]
  buffer_load_dwordx4 v[208:211], v124, s[32:35], s80 offen sc1
  s_add_u32 s80, s80, 1024
  ds_read_b64_tr_b16 v[48:49], v120 offset:0
  ds_read_b64_tr_b16 v[50:51], v120 offset:1024
  ds_read_b64_tr_b16 v[52:53], v121 offset:0
  ds_read_b64_tr_b16 v[54:55], v121 offset:1024
  s_waitcnt lgkmcnt(8)
  s_waitcnt vmcnt(11)
  v_mfma_f32_32x32x16_bf16 v[16:31], v[56:59], v[216:219], v[16:31]
  v_mfma_f32_32x32x16_bf16 v[32:47], v[60:63], v[216:219], v[32:47]
  buffer_load_dwordx4 v[212:215], v124, s[32:35], s80 offen sc1
  s_add_u32 s80, s80, 1024
  ds_read_b64_tr_b16 v[56:57], v120 offset:8192
  ds_read_b64_tr_b16 v[58:59], v120 offset:9216
  ds_read_b64_tr_b16 v[60:61], v121 offset:8192
  ds_read_b64_tr_b16 v[62:63], v121 offset:9216
  s_waitcnt lgkmcnt(8)
  s_waitcnt vmcnt(10)
  v_mfma_f32_32x32x16_bf16 v[16:31], v[64:67], v[220:223], v[16:31]
  v_mfma_f32_32x32x16_bf16 v[32:47], v[68:71], v[220:223], v[32:47]
  buffer_load_dwordx4 v[216:219], v124, s[32:35], s80 offen sc1
  s_add_u32 s80, s80, 1024
  ds_read_b64_tr_b16 v[64:65], v120 offset:16384
  ds_read_b64_tr_b16 v[66:67], v120 offset:17408
  ds_read_b64_tr_b16 v[68:69], v121 offset:16384
  ds_read_b64_tr_b16 v[70:71], v121 offset:17408
  s_waitcnt lgkmcnt(8)
  s_waitcnt vmcnt(9)
  v_mfma_f32_32x32x16_bf16 v[16:31], v[48:51], v[224:227], v[16:31]
  v_mfma_f32_32x32x16_bf16 v[32:47], v[52:55], v[224:227], v[32:47]
  buffer_load_dwordx4 v[220:223], v124, s[32:35], s80 offen sc1
  s_add_u32 s80, s80, 1024
  ds_read_b64_tr_b16 v[48:49], v120 offset:24576
  ds_read_b64_tr_b16 v[50:51], v120 offset:25600
  ds_read_b64_tr_b16 v[52:53], v121 offset:24576
  ds_read_b64_tr_b16 v[54:55], v121 offset:25600
  s_waitcnt lgkmcnt(8)
  s_waitcnt vmcnt(8)
  v_mfma_f32_32x32x16_bf16 v[16:31], v[56:59], v[228:231], v[16:31]
  v_mfma_f32_32x32x16_bf16 v[32:47], v[60:63], v[228:231], v[32:47]
  buffer_load_dwordx4 v[224:227], v124, s[32:35], s80 offen sc1
  s_add_u32 s80, s80, 1024
  s_waitcnt vmcnt(22)
  s_mov_b32 s86, 400000
L_gb_92:
  v_cmp_ne_u32 vcc, s53, v81
  v_cmp_ne_u32 s[96:97], s53, v83
  s_or_b64 vcc, vcc, s[96:97]
  v_cmp_ne_u32 s[96:97], s53, v85
  s_or_b64 vcc, vcc, s[96:97]
  v_cmp_ne_u32 s[96:97], s53, v87
  s_or_b64 vcc, vcc, s[96:97]
  s_cbranch_vccz L_gbo_93
  s_sub_u32 s86, s86, 1
  s_cmp_eq_u32 s86, 0
  s_cbranch_scc1 L_gbo_93
  s_mul_i32 s54, s90, 16384
  s_add_u32 s54, s54, 524288
  s_lshl_b32 s55, s74, 2
  s_add_u32 s54, s54, s55
  v_lshrrev_b32 v6, 5, v1
  v_lshlrev_b32 v6, 4, v6
  v_add_u32 v6, s54, v6
  s_mov_b32 s54, 10240
  buffer_load_dwordx4 v[80:83], v6, s[32:35], s54 offen sc1
  buffer_load_dwordx4 v[84:87], v6, s[32:35], s54 offen offset:32 sc1
  s_waitcnt vmcnt(0)
  s_branch L_gb_92
L_gbo_93:
  v_lshlrev_b32 v72, 16, v80
  v_and_b32 v73, 0xffff0000, v80
  v_lshlrev_b32 v74, 16, v82
  v_and_b32 v75, 0xffff0000, v82
  v_lshlrev_b32 v76, 16, v84
  v_and_b32 v77, 0xffff0000, v84
  v_lshlrev_b32 v78, 16, v86
  v_and_b32 v79, 0xffff0000, v86
  v_and_b32 v2, 31, v1
  v_add_u32 v2, s76, v2
  v_lshlrev_b32 v2, 10, v2
  v_lshrrev_b32 v3, 5, v1
  v_lshlrev_b32 v3, 4, v3
  s_lshl_b32 s54, s74, 1
  v_add3_u32 v88, v2, v3, s54
  s_mov_b32 s36, s26
  s_mov_b32 s37, s27
  s_mov_b32 s38, 2097152
  s_mov_b32 s39, 0x20000
  ds_read_b64_tr_b16 v[56:57], v118 offset:0
  ds_read_b64_tr_b16 v[58:59], v118 offset:1024
  ds_read_b64_tr_b16 v[60:61], v119 offset:0
  ds_read_b64_tr_b16 v[62:63], v119 offset:1024
  s_waitcnt lgkmcnt(8)
  s_waitcnt vmcnt(7)
  v_mfma_f32_32x32x16_bf16 v[16:31], v[64:67], v[232:235], v[16:31]
  v_mfma_f32_32x32x16_bf16 v[32:47], v[68:71], v[232:235], v[32:47]
  buffer_load_dwordx4 v[228:231], v124, s[32:35], s80 offen sc1
  s_add_u32 s80, s80, 1024
  ds_read_b64_tr_b16 v[64:65], v118 offset:8192
  ds_read_b64_tr_b16 v[66:67], v118 offset:9216
  ds_read_b64_tr_b16 v[68:69], v119 offset:8192
  ds_read_b64_tr_b16 v[70:71], v119 offset:9216
  s_waitcnt lgkmcnt(8)
  s_waitcnt vmcnt(6)
  v_mfma_f32_32x32x16_bf16 v[16:31], v[48:51], v[236:239], v[16:31]
  v_mfma_f32_32x32x16_bf16 v[32:47], v[52:55], v[236:239], v[32:47]
  buffer_load_dwordx4 v[232:235], v124, s[32:35], s80 offen sc1
  s_add_u32 s80, s80, 1024
  ds_read_b64_tr_b16 v[48:49], v118 offset:16384
  ds_read_b64_tr_b16 v[50:51], v118 offset:17408
  ds_read_b64_tr_b16 v[52:53], v119 offset:16384
  ds_read_b64_tr_b16 v[54:55], v119 offset:17408
  s_waitcnt lgkmcnt(8)
  s_waitcnt vmcnt(6)
  v_mfma_f32_32x32x16_bf16 v[16:31], v[56:59], v[208:211], v[16:31]
  v_mfma_f32_32x32x16_bf16 v[32:47], v[60:63], v[208:211], v[32:47]
  buffer_load_dwordx4 v[236:239], v124, s[32:35], s80 offen sc1
  s_add_u32 s80, s80, 1024
  ds_read_b64_tr_b16 v[56:57], v118 offset:24576
  ds_read_b64_tr_b16 v[58:59], v118 offset:25600
  ds_read_b64_tr_b16 v[60:61], v119 offset:24576
  ds_read_b64_tr_b16 v[62:63], v119 offset:25600
  s_waitcnt lgkmcnt(8)
  s_waitcnt vmcnt(6)
  v_mfma_f32_32x32x16_bf16 v[16:31], v[64:67], v[212:215], v[16:31]
  v_mfma_f32_32x32x16_bf16 v[32:47], v[68:71], v[212:215], v[32:47]
  buffer_load_dwordx4 v[208:211], v124, s[32:35], s80 offen sc1
  s_add_u32 s80, s80, 1024
  s_waitcnt vmcnt(18)
  s_barrier
  ds_read_b64_tr_b16 v[64:65], v125 offset:0
  ds_read_b64_tr_b16 v[66:67], v125 offset:1024
  ds_read_b64_tr_b16 v[68:69], v126 offset:0
  ds_read_b64_tr_b16 v[70:71], v126 offset:1024
  s_waitcnt lgkmcnt(8)
  s_waitcnt vmcnt(6)
  v_mfma_f32_32x32x16_bf16 v[16:31], v[48:51], v[216:219], v[16:31]
  v_mfma_f32_32x32x16_bf16 v[32:47], v[52:55], v[216:219], v[32:47]
  buffer_load_dwordx4 v[212:215], v124, s[32:35], s80 offen sc1
  s_add_u32 s80, s80, 1024
  ds_read_b64_tr_b16 v[48:49], v125 offset:8192
  ds_read_b64_tr_b16 v[50:51], v125 offset:9216
  ds_read_b64_tr_b16 v[52:53], v126 offset:8192
  ds_read_b64_tr_b16 v[54:55], v126 offset:9216
  s_waitcnt lgkmcnt(8)
  s_waitcnt vmcnt(6)
  v_mfma_f32_32x32x16_bf16 v[16:31], v[56:59], v[220:223], v[16:31]
  v_mfma_f32_32x32x16_bf16 v[32:47], v[60:63], v[220:223], v[32:47]
  buffer_load_dwordx4 v[216:219], v124, s[32:35], s80 offen sc1
  s_add_u32 s80, s80, 1024
  ds_read_b64_tr_b16 v[56:57], v125 offset:16384
  ds_read_b64_tr_b16 v[58:59], v125 offset:17408
  ds_read_b64_tr_b16 v[60:61], v126 offset:16384
  ds_read_b64_tr_b16 v[62:63], v126 offset:17408
  s_waitcnt lgkmcnt(8)
  s_waitcnt vmcnt(6)
  v_mfma_f32_32x32x16_bf16 v[16:31], v[64:67], v[224:227], v[16:31]
  v_mfma_f32_32x32x16_bf16 v[32:47], v[68:71], v[224:227], v[32:47]
  buffer_load_dwordx4 v[220:223], v124, s[32:35], s80 offen sc1
  ds_read_b64_tr_b16 v[64:65], v125 offset:24576
  ds_read_b64_tr_b16 v[66:67], v125 offset:25600
  ds_read_b64_tr_b16 v[68:69], v126 offset:24576
  ds_read_b64_tr_b16 v[70:71], v126 offset:25600
  s_waitcnt lgkmcnt(8)
  s_waitcnt vmcnt(6)
  v_mfma_f32_32x32x16_bf16 v[16:31], v[48:51], v[228:231], v[16:31]
  v_mfma_f32_32x32x16_bf16 v[32:47], v[52:55], v[228:231], v[32:47]
  s_waitcnt vmcnt(13)
  s_barrier
  ds_read_b64_tr_b16 v[48:49], v125 offset:32768
  ds_read_b64_tr_b16 v[50:51], v125 offset:33792
  ds_read_b64_tr_b16 v[52:53], v126 offset:32768
  ds_read_b64_tr_b16 v[54:55], v126 offset:33792
  s_waitcnt lgkmcnt(8)
  s_waitcnt vmcnt(5)
  v_mfma_f32_32x32x16_bf16 v[16:31], v[56:59], v[232:235], v[16:31]
  v_mfma_f32_32x32x16_bf16 v[32:47], v[60:63], v[232:235], v[32:47]
  ds_read_b64_tr_b16 v[56:57], v125 offset:40960
  ds_read_b64_tr_b16 v[58:59], v125 offset:41984
  ds_read_b64_tr_b16 v[60:61], v126 offset:40960
  ds_read_b64_tr_b16 v[62:63], v126 offset:41984
  s_waitcnt lgkmcnt(8)
  s_waitcnt vmcnt(4)
  v_mfma_f32_32x32x16_bf16 v[16:31], v[64:67], v[236:239], v[16:31]
  v_mfma_f32_32x32x16_bf16 v[32:47], v[68:71], v[236:239], v[32:47]
  ds_read_b64_tr_b16 v[64:65], v120 offset:32768
  ds_read_b64_tr_b16 v[66:67], v120 offset:33792
  ds_read_b64_tr_b16 v[68:69], v121 offset:32768
  ds_read_b64_tr_b16 v[70:71], v121 offset:33792
  s_waitcnt lgkmcnt(8)
  s_waitcnt vmcnt(3)
  v_mfma_f32_32x32x16_bf16 v[16:31], v[48:51], v[208:211], v[16:31]
  v_mfma_f32_32x32x16_bf16 v[32:47], v[52:55], v[208:211], v[32:47]
  ds_read_b64_tr_b16 v[48:49], v120 offset:40960
  ds_read_b64_tr_b16 v[50:51], v120 offset:41984
  ds_read_b64_tr_b16 v[52:53], v121 offset:40960
  ds_read_b64_tr_b16 v[54:55], v121 offset:41984
  s_waitcnt lgkmcnt(8)
  s_waitcnt vmcnt(2)
  v_mfma_f32_32x32x16_bf16 v[16:31], v[56:59], v[212:215], v[16:31]
  v_mfma_f32_32x32x16_bf16 v[32:47], v[60:63], v[212:215], v[32:47]
  s_waitcnt lgkmcnt(4)
  s_waitcnt vmcnt(1)
  v_mfma_f32_32x32x16_bf16 v[16:31], v[64:67], v[216:219], v[16:31]
  v_mfma_f32_32x32x16_bf16 v[32:47], v[68:71], v[216:219], v[32:47]
  s_waitcnt lgkmcnt(0)
  s_waitcnt vmcnt(0)
  v_mfma_f32_32x32x16_bf16 v[16:31], v[48:51], v[220:223], v[16:31]
  v_mfma_f32_32x32x16_bf16 v[32:47], v[52:55], v[220:223], v[32:47]
  s_barrier
  s_mul_i32 s54, s95, 32768
  s_lshl_b32 s55, s87, 11
  s_add_u32 s54, s54, s55
  s_add_u32 s54, s54, 0
  v_lshlrev_b32 v2, 4, v1
  v_add_u32 v3, s54, v2
  s_nop 3
  ds_write_b128 v3, v[16:19] offset:0
  ds_write_b128 v3, v[20:23] offset:1024
  ds_write_b128 v3, v[24:27] offset:8192
  ds_write_b128 v3, v[28:31] offset:9216
  ds_write_b128 v3, v[32:35] offset:16384
  ds_write_b128 v3, v[36:39] offset:17408
  ds_write_b128 v3, v[40:43] offset:24576
  ds_write_b128 v3, v[44:47] offset:25600
  s_mul_i32 s54, s95, 32768
  s_lshr_b32 s55, s87, 1
  s_mul_i32 s55, s55, 16384
  s_add_u32 s54, s54, s55
  s_and_b32 s55, s87, 1
  s_lshl_b32 s55, s55, 13
  s_add_u32 s54, s54, s55
  s_add_u32 s54, s54, 0
  v_add_u32 v3, s54, v2
  s_waitcnt lgkmcnt(0)
  s_barrier
  ds_read_b128 v[16:19], v3 offset:0
  ds_read_b128 v[20:23], v3 offset:1024
  ds_read_b128 v[24:27], v3 offset:2048
  ds_read_b128 v[28:31], v3 offset:3072
  ds_read_b128 v[32:35], v3 offset:4096
  ds_read_b128 v[36:39], v3 offset:5120
  ds_read_b128 v[40:43], v3 offset:6144
  ds_read_b128 v[44:47], v3 offset:7168
  s_waitcnt lgkmcnt(4)
  v_add_f32 v48, v16, v24
  v_add_f32 v49, v17, v25
  v_add_f32 v50, v18, v26
  v_add_f32 v51, v19, v27
  v_add_f32 v52, v20, v28
  v_add_f32 v53, v21, v29
  v_add_f32 v54, v22, v30
  v_add_f32 v55, v23, v31
  s_waitcnt lgkmcnt(0)
  v_add_f32 v32, v32, v40
  v_add_f32 v33, v33, v41
  v_add_f32 v34, v34, v42
  v_add_f32 v35, v35, v43
  v_add_f32 v36, v36, v44
  v_add_f32 v37, v37, v45
  v_add_f32 v38, v38, v46
  v_add_f32 v39, v39, v47
  v_add_f32 v48, v48, v32
  v_add_f32 v49, v49, v33
  v_add_f32 v50, v50, v34
  v_add_f32 v51, v51, v35
  v_add_f32 v52, v52, v36
  v_add_f32 v53, v53, v37
  v_add_f32 v54, v54, v38
  v_add_f32 v55, v55, v39
  v_fma_f32 v48, v72, v48, v104
  v_fma_f32 v49, v73, v49, v105
  v_fma_f32 v50, v74, v50, v106
  v_fma_f32 v51, v75, v51, v107
  v_fma_f32 v52, v76, v52, v108
  v_fma_f32 v53, v77, v53, v109
  v_fma_f32 v54, v78, v54, v110
  v_fma_f32 v55, v79, v55, v111
  v_cvt_pk_bf16_f32 v16, v48, v49
  v_cvt_pk_bf16_f32 v17, v50, v51
  v_cvt_pk_bf16_f32 v18, v52, v53
  v_cvt_pk_bf16_f32 v19, v54, v55
  s_nop 1
  v_permlane32_swap_b32 v16, v18
  v_permlane32_swap_b32 v17, v19
  buffer_store_dwordx4 v[16:19], v88, s[36:39], 0 offen
L_exit:
  s_endpgm
L_slow:
  s_mov_b32 s93, 1
  v_mov_b32 v2, v112
  v_mov_b32 v4, 0xff800000
  v_mov_b32 v5, 0xff800000
  s_mov_b32 s54, 32
L_slow1:
  ds_read_b128 v[88:91], v2
  v_add_u32 v2, 1024, v2
  s_waitcnt lgkmcnt(0)
  v_mfma_f32_32x32x16_bf16 v[16:31], v[88:91], v[8:11], 0
  v_mfma_f32_32x32x16_bf16 v[32:47], v[88:91], v[12:15], 0
  s_nop 10
  v_max3_f32 v4, v4, v16, v17
  v_max3_f32 v4, v4, v18, v19
  v_max3_f32 v4, v4, v20, v21
  v_max3_f32 v4, v4, v22, v23
  v_max3_f32 v4, v4, v24, v25
  v_max3_f32 v4, v4, v26, v27
  v_max3_f32 v4, v4, v28, v29
  v_max3_f32 v4, v4, v30, v31
  v_max3_f32 v5, v5, v32, v33
  v_max3_f32 v5, v5, v34, v35
  v_max3_f32 v5, v5, v36, v37
  v_max3_f32 v5, v5, v38, v39
  v_max3_f32 v5, v5, v40, v41
  v_max3_f32 v5, v5, v42, v43
  v_max3_f32 v5, v5, v44, v45
  v_max3_f32 v5, v5, v46, v47
  s_sub_u32 s54, s54, 1
  s_cmp_lg_u32 s54, 0
  s_cbranch_scc1 L_slow1
  v_mov_b32 v6, v4
  v_mov_b32 v7, v5
  s_nop 1
  v_permlane32_swap_b32 v4, v6
  v_permlane32_swap_b32 v5, v7
  s_nop 1
  v_max_f32 v4, v4, v6
  v_max_f32 v5, v5, v7
  v_lshlrev_b32 v2, 3, v1
  v_add_u32 v3, s70, v2
  s_xor_b32 s54, s52, 4
  s_lshl_b32 s54, s54, 12
  s_add_u32 s54, s54, 131072
  v_add_u32 v2, s54, v2
  ds_write_b64 v3, v[4:5]
  s_waitcnt lgkmcnt(0)
  s_barrier
  ds_read_b64 v[6:7], v2
  s_waitcnt lgkmcnt(0)
  v_max_f32 v4, v4, v6
  v_max_f32 v5, v5, v7
  s_barrier
  v_mov_b32 v48, 0
  v_mov_b32 v49, 0
  v_mov_b32 v50, 0
  v_mov_b32 v51, 0
  v_mov_b32 v52, 0
  v_mov_b32 v53, 0
  v_mov_b32 v54, 0
  v_mov_b32 v55, 0
  v_mov_b32 v56, 0
  v_mov_b32 v57, 0
  v_mov_b32 v58, 0
  v_mov_b32 v59, 0
  v_mov_b32 v60, 0
  v_mov_b32 v61, 0
  v_mov_b32 v62, 0
  v_mov_b32 v63, 0
  v_mov_b32 v64, 0
  v_mov_b32 v65, 0
  v_mov_b32 v66, 0
  v_mov_b32 v67, 0
  v_mov_b32 v68, 0
  v_mov_b32 v69, 0
  v_mov_b32 v70, 0
  v_mov_b32 v71, 0
  v_mov_b32 v72, 0
  v_mov_b32 v73, 0
  v_mov_b32 v74, 0
  v_mov_b32 v75, 0
  v_mov_b32 v76, 0
  v_mov_b32 v77, 0
  v_mov_b32 v78, 0
  v_mov_b32 v79, 0
  v_mov_b32 v2, v112
  v_mov_b32 v3, v113
  s_mov_b32 s54, 32
L_slow2:
  ds_read_b128 v[88:91], v2
  s_mov_b64 exec, s[72:73]
  ds_read_b128 v[96:99], v3
  ds_read_b128 v[100:103], v3 offset:512
  s_mov_b64 exec, -1
  v_add_u32 v2, 1024, v2
  v_add_u32 v3, 1024, v3
  s_waitcnt lgkmcnt(0)
  v_mfma_f32_32x32x16_bf16 v[16:31], v[88:91], v[8:11], 0
  v_mfma_f32_32x32x16_bf16 v[32:47], v[88:91], v[12:15], 0
  s_nop 10
  v_sub_f32 v16, v16, v4
  v_sub_f32 v17, v17, v4
  v_sub_f32 v18, v18, v4
  v_sub_f32 v19, v19, v4
  v_sub_f32 v20, v20, v4
  v_sub_f32 v21, v21, v4
  v_sub_f32 v22, v22, v4
  v_sub_f32 v23, v23, v4
  v_sub_f32 v24, v24, v4
  v_sub_f32 v25, v25, v4
  v_sub_f32 v26, v26, v4
  v_sub_f32 v27, v27, v4
  v_sub_f32 v28, v28, v4
  v_sub_f32 v29, v29, v4
  v_sub_f32 v30, v30, v4
  v_sub_f32 v31, v31, v4
  v_exp_f32 v16, v16
  v_exp_f32 v17, v17
  v_exp_f32 v18, v18
  v_exp_f32 v19, v19
  v_exp_f32 v20, v20
  v_exp_f32 v21, v21
  v_exp_f32 v22, v22
  v_exp_f32 v23, v23
  v_exp_f32 v24, v24
  v_exp_f32 v25, v25
  v_exp_f32 v26, v26
  v_exp_f32 v27, v27
  v_exp_f32 v28, v28
  v_exp_f32 v29, v29
  v_exp_f32 v30, v30
  v_exp_f32 v31, v31
  v_cvt_pk_bf16_f32 v80, v16, v17
  v_cvt_pk_bf16_f32 v81, v18, v19
  v_cvt_pk_bf16_f32 v82, v20, v21
  v_cvt_pk_bf16_f32 v83, v22, v23
  v_cvt_pk_bf16_f32 v84, v24, v25
  v_cvt_pk_bf16_f32 v85, v26, v27
  v_cvt_pk_bf16_f32 v86, v28, v29
  v_cvt_pk_bf16_f32 v87, v30, v31
  v_mfma_f32_32x32x16_bf16 v[48:63], v[96:99], v[80:83], v[48:63]
  s_nop 0
  v_mfma_f32_32x32x16_bf16 v[48:63], v[100:103], v[84:87], v[48:63]
  v_sub_f32 v32, v32, v5
  v_sub_f32 v33, v33, v5
  v_sub_f32 v34, v34, v5
  v_sub_f32 v35, v35, v5
  v_sub_f32 v36, v36, v5
  v_sub_f32 v37, v37, v5
  v_sub_f32 v38, v38, v5
  v_sub_f32 v39, v39, v5
  v_sub_f32 v40, v40, v5
  v_sub_f32 v41, v41, v5
  v_sub_f32 v42, v42, v5
  v_sub_f32 v43, v43, v5
  v_sub_f32 v44, v44, v5
  v_sub_f32 v45, v45, v5
  v_sub_f32 v46, v46, v5
  v_sub_f32 v47, v47, v5
  v_exp_f32 v32, v32
  v_exp_f32 v33, v33
  v_exp_f32 v34, v34
  v_exp_f32 v35, v35
  v_exp_f32 v36, v36
  v_exp_f32 v37, v37
  v_exp_f32 v38, v38
  v_exp_f32 v39, v39
  v_exp_f32 v40, v40
  v_exp_f32 v41, v41
  v_exp_f32 v42, v42
  v_exp_f32 v43, v43
  v_exp_f32 v44, v44
  v_exp_f32 v45, v45
  v_exp_f32 v46, v46
  v_exp_f32 v47, v47
  v_cvt_pk_bf16_f32 v80, v32, v33
  v_cvt_pk_bf16_f32 v81, v34, v35
  v_cvt_pk_bf16_f32 v82, v36, v37
  v_cvt_pk_bf16_f32 v83, v38, v39
  v_cvt_pk_bf16_f32 v84, v40, v41
  v_cvt_pk_bf16_f32 v85, v42, v43
  v_cvt_pk_bf16_f32 v86, v44, v45
  v_cvt_pk_bf16_f32 v87, v46, v47
  v_mfma_f32_32x32x16_bf16 v[64:79], v[96:99], v[80:83], v[64:79]
  s_nop 0
  v_mfma_f32_32x32x16_bf16 v[64:79], v[100:103], v[84:87], v[64:79]
  s_sub_u32 s54, s54, 1
  s_cmp_lg_u32 s54, 0
  s_cbranch_scc1 L_slow2
  s_nop 15
  s_branch L_fin
L_codeend:
.section .rodata,"a"
.p2align 6
.amdhsa_kernel adaLN_cond__grouped_kv_mqa__swiglu_ffn__prompt_kernel
  .amdhsa_next_free_vgpr 256
  .amdhsa_next_free_sgpr 102
  .amdhsa_accum_offset 256
  .amdhsa_group_segment_fixed_size 0
  .amdhsa_kernarg_size 112
  .amdhsa_user_sgpr_count 2
  .amdhsa_user_sgpr_kernarg_segment_ptr 1
  .amdhsa_system_sgpr_workgroup_id_x 1
.end_amdhsa_kernel
```
